```python
import torch

def _softmax(x, axis=-1):
    return torch.softmax(x, dim=axis)

def _gelu(x):
    return torch.nn.functional.gelu(x, approximate='tanh')

def _silu(x):
    return torch.nn.functional.silu(x)

def _sigmoid(x):
    return torch.sigmoid(x)

def _layernorm(x, axis=-1, eps=1e-05):
    m = x.mean(dim=axis, keepdim=True)
    v = x.var(dim=axis, keepdim=True, unbiased=False)
    return (x - m) / torch.sqrt(v + eps)

def _scatter_add(tgt, idx, src, axis=0):
    return tgt.clone().index_add_(axis, idx, src)

def _segment_sum(src, seg, n):
    out = torch.zeros((n,) + src.shape[1:], dtype=src.dtype)
    return out.index_add_(0, seg, src)

def _pad(x, pw):
    flat = tuple((v for pair in reversed(pw) for v in pair))
    return torch.nn.functional.pad(x, flat)
kernel_name = 'adaLN_cond__sliding_block_cached__glu_gated_bilinear__decode'

def setup_inputs():

    _w = lambda a: (lambda t: t.to(torch.bfloat16) if t.is_floating_point() else t)(torch.as_tensor(a))

    def _A_setup():
        B, Sq, D = (1, 1, 512)
        Hq, Hkv, Sk, Dh = (32, 8, 65536, 128)
        assert Hq % Hkv == 0, (Hq, Hkv)
        return {'x': _w((lambda *s: torch.randn(*s, dtype=torch.bfloat16) * 0.1)(B, Sq, D)), 'k_cache': _w((lambda *s: torch.randn(*s, dtype=torch.bfloat16) * 0.8)(B, Hkv, Sk, Dh)), 'v_cache': _w((lambda *s: torch.randn(*s, dtype=torch.bfloat16) * 3.2)(B, Hkv, Sk, Dh)), 'wq': _w((lambda *s: torch.randn(*s, dtype=torch.bfloat16) * 0.8)(D, Hq * Dh) * D ** (-0.5)), 'wo': _w((lambda *s: torch.randn(*s, dtype=torch.bfloat16) * 3.2)(Hq * Dh, D) * (Hq * Dh) ** (-0.5))}
    _A_in = _A_setup()

    def _B_setup():
        B, S, D, F = (1, 1, 512, 1792)
        return {'x': _w((lambda *s: torch.randn(*s, dtype=torch.bfloat16) * 0.1)(B, S, D)), 'w_gate': _w((lambda *s: torch.randn(*s, dtype=torch.bfloat16) * 3.2)(D, F) * D ** (-0.5)), 'w_up': _w((lambda *s: torch.randn(*s, dtype=torch.bfloat16) * 3.2)(D, F) * D ** (-0.5)), 'w_down': _w((lambda *s: torch.randn(*s, dtype=torch.bfloat16) * 3.2)(F, D) * F ** (-0.5))}
    _B_in = _B_setup()
    return {'A_x': _A_in['x'], 'A_k_cache': _A_in['k_cache'], 'A_v_cache': _A_in['v_cache'], 'A_wq': _A_in['wq'], 'A_wo': _A_in['wo'], 'B_x': _B_in['x'], 'B_w_gate': _B_in['w_gate'], 'B_w_up': _B_in['w_up'], 'B_w_down': _B_in['w_down'], 'c': _w((lambda *s: torch.randn(*s, dtype=torch.bfloat16) * 0.4)(1, 512) * 8.0), 'w_mod': _w((lambda *s: torch.randn(*s, dtype=torch.bfloat16) * 0.4)(512, 6 * 512) * 512 ** (-0.5) * 8.0)}

def reference(A_x, A_k_cache, A_v_cache, A_wq, A_wo, B_x, B_w_gate, B_w_up, B_w_down, c, w_mod):

    def _A_ref(x, k_cache, v_cache, wq, wo):
        B, Sq, D = x.shape
        Hq, Dh = (32, 128)
        Hkv, Sk = (k_cache.shape[1], k_cache.shape[2])
        W = min(4096, max(256, Sk // 4))
        rep = Hq // Hkv
        q = (lambda x, *d: x.permute(*d))((x @ wq).reshape(B, Sq, Hq, Dh), 0, 2, 1, 3)
        k = (lambda x, n, axis: torch.repeat_interleave(x, n, dim=axis))(k_cache[:, :, Sk - W:, :], rep, axis=1)
        v = (lambda x, n, axis: torch.repeat_interleave(x, n, dim=axis))(v_cache[:, :, Sk - W:, :], rep, axis=1)
        scores = torch.einsum('bhqd,bhkd->bhqk', q, k) * Dh ** (-0.5)
        p = _softmax(scores, axis=-1)
        o = torch.einsum('bhqk,bhkd->bhqd', p, v)
        return (lambda x, *d: x.permute(*d))(o, 0, 2, 1, 3).reshape(B, Sq, Hq * Dh) @ wo

    def _B_ref(x, w_gate, w_up, w_down):
        g = torch.einsum('bsd,df->bsf', x, w_gate)
        u = torch.einsum('bsd,df->bsf', x, w_up)
        h = g * u
        return torch.einsum('bsf,fd->bsd', h, w_down)
    x = A_x
    mod = (_silu(c) @ w_mod).reshape(c.shape[0], 6, 1, -1)
    sa, ca, ga, sb, cb, gb = (mod[:, 0].clone(), mod[:, 1].clone(), mod[:, 2].clone(), mod[:, 3].clone(), mod[:, 4].clone(), mod[:, 5].clone())
    h = _layernorm(x, axis=-1) * (1 + ca) + sa
    x = x + ga * _A_ref(h, A_k_cache, A_v_cache, A_wq, A_wo)
    h = _layernorm(x, axis=-1) * (1 + cb) + sb
    x = x + gb * _B_ref(h, B_w_gate, B_w_up, B_w_down)
    return x
```

```asm
; @launch grid=(256,1,1) block=(320,1,1) lds=57600
.amdgcn_target "amdgcn-amd-amdhsa--gfx950"
.text
.globl adaLN_cond__sliding_block_cached__glu_gated_bilinear__decode_kernel
.p2align 8
.type adaLN_cond__sliding_block_cached__glu_gated_bilinear__decode_kernel,@function
adaLN_cond__sliding_block_cached__glu_gated_bilinear__decode_kernel:
    s_load_dwordx16 s[4:19], s[0:1], 0
    s_load_dwordx8 s[20:27], s[0:1], 64
    s_load_dwordx4 s[28:31], s[0:1], 96
    s_getpc_b64 s[54:55]
    s_cmp_ge_u32 s2, 256
    s_cbranch_scc1 L_end
    s_lshr_b32 s33, s2, 3
    v_lshrrev_b32 v22, 6, v0
    s_mul_i32 s35, s33, 5
    v_add_u32 v23, s35, v22
    v_min_u32 v23, 118, v23
    v_lshlrev_b32 v23, 7, v23
    global_load_dword v11, v23, s[54:55]
    v_and_b32 v1, 63, v0
    v_readfirstlane_b32 s34, v22
    s_and_b32 s32, s2, 7
    v_lshrrev_b32 v2, 3, v1
    v_and_b32 v3, 7, v1
    v_mov_b32 v10, 0
    v_lshlrev_b32 v4, 4, v1
    s_cmp_lt_u32 s33, 16
    s_cbranch_scc1 L_A0
    s_cmp_eq_u32 s34, 4
    s_cbranch_scc1 L_end
    s_sub_u32 s44, s33, 16
    s_lshl_b32 s35, s32, 6
    s_lshl_b32 s38, s34, 4
    s_add_u32 s35, s35, s38
    v_lshl_add_u32 v22, v2, 1, s35
    v_lshlrev_b32 v23, 1, v22
    s_lshl_b32 s37, s44, 7
    v_mul_u32_u24 v22, 6144, v22
    v_lshl_add_u32 v22, v3, 4, v22
    v_add_u32 v22, s37, v22
    v_add_u32 v27, 6144, v22
    s_and_b32 s35, s44, 1
    s_lshl_b32 s35, s35, 8
    s_lshl_b32 s38, s34, 6
    s_add_u32 s35, s35, s38
    s_lshr_b32 s37, s44, 1
    s_lshl_b32 s36, s35, 13
    s_lshl_b32 s38, s32, 10
    s_add_u32 s36, s36, s38
    s_lshl_b32 s38, s37, 7
    s_add_u32 s36, s36, s38
    v_lshlrev_b32 v26, 16, v2
    v_lshl_add_u32 v26, v3, 4, v26
    v_add_u32 v26, s36, v26
    s_waitcnt lgkmcnt(0)
    global_load_dword v173, v23, s[22:23]
    global_load_dwordx4 v[156:159], v22, s[24:25] nt
    global_load_dwordx4 v[160:163], v27, s[24:25] nt
    global_load_dword v6, v10, s[30:31] sc1
    v_lshrrev_b32 v8, 4, v1
    v_and_b32 v9, 15, v1
    v_bfe_u32 v25, v1, 4, 1
    v_lshrrev_b32 v24, 5, v1
    v_lshl_add_u32 v7, v25, 1, v24
    v_lshl_add_u32 v25, v9, 2, v7
    v_add_lshl_u32 v25, v25, s35, 1
    v_mov_b32 v172, 0
    s_barrier
    global_load_dwordx4 v[152:155], v4, s[4:5]
    global_load_short_d16_hi v172, v25, s[4:5]
    global_load_dwordx4 v[120:123], v26, s[10:11] nt
    v_add_u32 v26, 8192, v26
    global_load_dwordx4 v[124:127], v26, s[10:11] nt
    v_add_u32 v26, 8192, v26
    global_load_dwordx4 v[128:131], v26, s[10:11] nt
    v_add_u32 v26, 8192, v26
    global_load_dwordx4 v[132:135], v26, s[10:11] nt
    v_add_u32 v26, 8192, v26
    global_load_dwordx4 v[136:139], v26, s[10:11] nt
    v_add_u32 v26, 8192, v26
    global_load_dwordx4 v[140:143], v26, s[10:11] nt
    v_add_u32 v26, 8192, v26
    global_load_dwordx4 v[144:147], v26, s[10:11] nt
    v_add_u32 v26, 8192, v26
    global_load_dwordx4 v[148:151], v26, s[10:11] nt
    s_and_b32 s35, s44, 3
    s_lshl_b32 s35, s35, 7
    s_lshl_b32 s38, s34, 5
    s_add_u32 s35, s35, s38
    v_lshl_add_u32 v119, v2, 2, s35
    v_lshlrev_b32 v28, 1, v119
    v_lshl_add_u32 v29, v3, 2, v7
    v_add_lshl_u32 v29, v29, s35, 1
    v_mov_b32 v118, 0
    global_load_dwordx2 v[116:117], v28, s[22:23]
    global_load_short_d16_hi v118, v29, s[4:5]
    s_mov_b32 s40, 0x3fb8aa3b
    s_mov_b32 s41, 0xffff0000
    s_movk_i32 s42, 0xff
    s_mov_b32 s46, 0x00ff00ff
    s_mov_b32 s47, 0xff00ff00
    s_mov_b32 s62, 0x11111111
    s_mov_b32 s63, 0x11111111
    v_lshlrev_b32 v12, 2, v1
    v_and_b32 v27, 1, v1
    v_lshlrev_b32 v27, 4, v27
    v_mov_b32 v29, 0xffff
    v_lshlrev_b32 v27, v27, v29
    v_lshrrev_b32 v29, 1, v3
    v_cmp_eq_u32 s[48:49], 0, v29
    v_cmp_eq_u32 s[50:51], 1, v29
    v_cmp_eq_u32 s[52:53], 2, v29
    v_cmp_eq_u32 s[54:55], 3, v29
    v_cndmask_b32 v14, 0, v27, s[48:49]
    v_cndmask_b32 v15, 0, v27, s[50:51]
    v_cndmask_b32 v16, 0, v27, s[52:53]
    v_cndmask_b32 v17, 0, v27, s[54:55]
    v_lshrrev_b32 v28, 5, v1
    v_bfe_u32 v29, v1, 4, 1
    s_lshl_b32 s38, s34, 9
    v_lshlrev_b32 v18, 8, v28
    v_lshl_add_u32 v18, v29, 4, v18
    v_lshl_add_u32 v18, v3, 5, v18
    v_add_u32 v18, s38, v18
    s_lshl_b32 s35, s34, 8
    s_add_u32 s35, s35, 4096
    v_lshlrev_b32 v19, 4, v9
    v_lshl_add_u32 v19, v7, 2, v19
    v_add_u32 v19, s35, v19
    v_lshl_add_u32 v20, v2, 5, s35
    s_add_u32 s60, s30, 983040
    s_addc_u32 s61, s31, 0
    s_lshl_b32 s35, s44, 11
    s_lshl_b32 s38, s32, 8
    s_add_u32 s35, s35, s38
    s_add_u32 s35, s35, 4096
    v_add_u32 v174, s35, v12
    s_waitcnt vmcnt(15)
    v_lshlrev_b32 v25, 16, v173
    v_and_b32 v26, s41, v173
    v_mul_f32 v27, s40, v25
    v_mul_f32 v29, s40, v26
    v_exp_f32 v27, -v27
    v_exp_f32 v29, -v29
    v_add_f32 v27, 1.0, v27
    v_add_f32 v29, 1.0, v29
    v_rcp_f32 v27, v27
    v_rcp_f32 v29, v29
    v_mul_f32 v27, v25, v27
    v_mul_f32 v29, v26, v29
    v_cvt_pk_bf16_f32 v22, v27, v27
    v_cvt_pk_bf16_f32 v23, v29, v29
    v_and_b32 v64, v22, v14
    v_and_b32 v65, v22, v15
    v_and_b32 v66, v22, v16
    v_and_b32 v67, v22, v17
    v_and_b32 v68, v23, v14
    v_and_b32 v69, v23, v15
    v_and_b32 v70, v23, v16
    v_and_b32 v71, v23, v17
    s_waitcnt vmcnt(14)
    v_mfma_f32_16x16x32_bf16 v[80:83], v[64:67], v[156:159], 0
    s_waitcnt vmcnt(12)
    v_mfma_f32_16x16x32_bf16 v[80:83], v[68:71], v[160:163], v[80:83]
    v_add_u32 v6, 1, v6
    v_and_b32 v5, 0xff, v6
    s_mov_b64 exec, s[46:47]
    s_nop 4
    ds_write_b128 v18, v[80:83] offset:0
    s_mov_b64 exec, -1
    s_cmp_lg_u32 s34, 0
    s_waitcnt lgkmcnt(0)
    s_barrier
    s_cbranch_scc1 L_trskip0
    ds_read2st64_b32 v[32:33], v12 offset0:0 offset1:1
    ds_read2st64_b32 v[34:35], v12 offset0:2 offset1:3
    ds_read2st64_b32 v[36:37], v12 offset0:4 offset1:5
    ds_read2st64_b32 v[38:39], v12 offset0:6 offset1:7
    s_waitcnt lgkmcnt(2)
    v_pk_add_f32 v[32:33], v[32:33], v[34:35]
    s_waitcnt lgkmcnt(0)
    v_pk_add_f32 v[36:37], v[36:37], v[38:39]
    v_pk_add_f32 v[32:33], v[32:33], v[36:37]
    v_add_f32 v32, v32, v33
    v_bfi_b32 v32, s42, v5, v32
    s_nop 1
    v_mov_b32_dpp v40, v32 quad_perm:[0,0,0,0] row_mask:0xf bank_mask:0xf
    v_mov_b32_dpp v41, v32 quad_perm:[1,1,1,1] row_mask:0xf bank_mask:0xf
    v_mov_b32_dpp v42, v32 quad_perm:[2,2,2,2] row_mask:0xf bank_mask:0xf
    v_mov_b32_dpp v43, v32 quad_perm:[3,3,3,3] row_mask:0xf bank_mask:0xf
    s_mov_b64 exec, s[62:63]
    global_store_dwordx4 v174, v[40:43], s[30:31] offset:0 sc1
    s_mov_b64 exec, -1
L_trskip0:
    s_waitcnt vmcnt(10)
    v_lshlrev_b32 v32, 16, v152
    v_and_b32 v33, s41, v152
    v_lshlrev_b32 v34, 16, v153
    v_and_b32 v35, s41, v153
    v_lshlrev_b32 v36, 16, v154
    v_and_b32 v37, s41, v154
    v_lshlrev_b32 v38, 16, v155
    v_and_b32 v39, s41, v155
    v_pk_add_f32 v[40:41], v[32:33], v[34:35]
    v_pk_add_f32 v[42:43], v[36:37], v[38:39]
    v_pk_add_f32 v[40:41], v[40:41], v[42:43]
    v_add_f32 v22, v40, v41
    s_nop 1
    v_add_f32_dpp v22, v22, v22 quad_perm:[1,0,3,2] row_mask:0xf bank_mask:0xf
    s_nop 1
    v_add_f32_dpp v22, v22, v22 quad_perm:[2,3,0,1] row_mask:0xf bank_mask:0xf
    s_nop 1
    v_add_f32_dpp v22, v22, v22 row_half_mirror row_mask:0xf bank_mask:0xf
    s_nop 1
    v_add_f32_dpp v22, v22, v22 row_mirror row_mask:0xf bank_mask:0xf
    v_mov_b32 v23, v22
    s_nop 1
    v_permlane16_swap_b32 v22, v23
    v_add_f32 v22, v22, v23
    v_mov_b32 v23, v22
    s_nop 1
    v_permlane32_swap_b32 v22, v23
    v_add_f32 v22, v22, v23
    v_mul_f32 v22, 0x3b000000, v22
    v_sub_f32 v32, v32, v22
    v_sub_f32 v33, v33, v22
    v_sub_f32 v34, v34, v22
    v_sub_f32 v35, v35, v22
    v_sub_f32 v36, v36, v22
    v_sub_f32 v37, v37, v22
    v_sub_f32 v38, v38, v22
    v_sub_f32 v39, v39, v22
    v_mul_f32 v24, v32, v32
    v_fmac_f32 v24, v33, v33
    v_fmac_f32 v24, v34, v34
    v_fmac_f32 v24, v35, v35
    v_fmac_f32 v24, v36, v36
    v_fmac_f32 v24, v37, v37
    v_fmac_f32 v24, v38, v38
    v_fmac_f32 v24, v39, v39
    s_nop 1
    v_add_f32_dpp v24, v24, v24 quad_perm:[1,0,3,2] row_mask:0xf bank_mask:0xf
    s_nop 1
    v_add_f32_dpp v24, v24, v24 quad_perm:[2,3,0,1] row_mask:0xf bank_mask:0xf
    s_nop 1
    v_add_f32_dpp v24, v24, v24 row_half_mirror row_mask:0xf bank_mask:0xf
    s_nop 1
    v_add_f32_dpp v24, v24, v24 row_mirror row_mask:0xf bank_mask:0xf
    v_mov_b32 v23, v24
    s_nop 1
    v_permlane16_swap_b32 v24, v23
    v_add_f32 v24, v24, v23
    v_mov_b32 v23, v24
    s_nop 1
    v_permlane32_swap_b32 v24, v23
    v_add_f32 v24, v24, v23
    v_mul_f32 v24, 0x3b000000, v24
    v_cvt_pk_bf16_f32 v24, v24, v24
    v_and_b32 v24, s41, v24
    v_cvt_pk_bf16_f32 v22, v22, v22
    v_and_b32 v22, s41, v22
    v_add_f32 v24, 0x3727c5ac, v24
    v_sub_f32 v25, v172, v22
    v_cvt_pk_bf16_f32 v24, v24, v24
    v_and_b32 v24, s41, v24
    v_cvt_pk_bf16_f32 v25, v25, v25
    v_and_b32 v25, s41, v25
    v_sqrt_f32 v24, v24
    s_nop 0
    v_cvt_pk_bf16_f32 v24, v24, v24
    v_and_b32 v24, s41, v24
    v_rcp_f32 v26, v24
    s_nop 0
    v_mul_f32 v27, v25, v26
    v_fma_f32 v25, -v27, v24, v25
    v_fma_f32 v27, v25, v26, v27
    v_cvt_pk_bf16_f32 v172, v27, v27
    v_and_b32 v172, s41, v172
    s_and_b32 s35, s44, 1
    s_lshl_b32 s35, s35, 13
    s_lshl_b32 s38, s34, 11
    s_add_u32 s35, s35, s38
    s_add_u32 s35, s35, 4096
    v_add_u32 v164, s35, v4
    v_add_u32 v165, 16384, v164
    v_bfe_u32 v22, v1, 2, 1
    s_lshl_b32 s35, s32, 12
    s_lshl_b32 s38, s44, 8
    s_add_u32 s35, s35, s38
    s_add_u32 s35, s35, 65536
    v_lshlrev_b32 v175, 7, v22
    v_lshl_add_u32 v175, v2, 4, v175
    v_add_u32 v175, s35, v175
    s_lshl_b32 s36, s32, 4
    s_add_u32 s36, s36, s44
    s_lshr_b32 s36, s36, 2
    s_lshl_b32 s36, s36, 7
    s_add_u32 s36, s36, 2048
    v_mul_u32_u24 v119, 6144, v119
    v_lshl_add_u32 v119, v3, 4, v119
    v_add_u32 v119, s36, v119
    s_and_b32 s36, s44, 1
    s_lshr_b32 s37, s44, 1
    s_lshl_b32 s35, s32, 19
    s_lshl_b32 s38, s36, 18
    s_add_u32 s35, s35, s38
    s_lshl_b32 s38, s34, 16
    s_add_u32 s35, s35, s38
    s_lshl_b32 s38, s37, 7
    s_add_u32 s35, s35, s38
    v_lshlrev_b32 v29, 10, v2
    v_lshl_add_u32 v29, v3, 4, v29
    v_add_u32 v29, s35, v29
    s_waitcnt vmcnt(3)
    s_mov_b32 s39, 20000
    global_load_dwordx4 v[32:35], v164, s[30:31] offset:0 sc1
    global_load_dwordx4 v[36:39], v164, s[30:31] offset:1024 sc1
    global_load_dwordx4 v[40:43], v165, s[30:31] offset:0 sc1
    global_load_dwordx4 v[44:47], v165, s[30:31] offset:1024 sc1
    s_waitcnt vmcnt(3)
L_chk0_0:
    v_xor_b32 v32, v5, v32
    v_xor_b32 v33, v5, v33
    v_xor_b32 v34, v5, v34
    v_xor_b32 v35, v5, v35
    v_or3_b32 v30, v32, v33, v34
    v_or_b32 v30, v30, v35
    v_cmp_ne_u32_sdwa vcc, v30, v10 src0_sel:BYTE_0 src1_sel:DWORD
    s_cbranch_vccnz L_rty0_0
L_ok0_0:
    s_waitcnt vmcnt(2)
L_chk0_1:
    v_xor_b32 v36, v5, v36
    v_xor_b32 v37, v5, v37
    v_xor_b32 v38, v5, v38
    v_xor_b32 v39, v5, v39
    v_or3_b32 v30, v36, v37, v38
    v_or_b32 v30, v30, v39
    v_cmp_ne_u32_sdwa vcc, v30, v10 src0_sel:BYTE_0 src1_sel:DWORD
    s_cbranch_vccnz L_rty0_1
L_ok0_1:
    v_pk_add_f32 v[32:33], v[32:33], v[36:37]
    v_pk_add_f32 v[34:35], v[34:35], v[38:39]
    s_waitcnt vmcnt(1)
L_chk0_2:
    v_xor_b32 v40, v5, v40
    v_xor_b32 v41, v5, v41
    v_xor_b32 v42, v5, v42
    v_xor_b32 v43, v5, v43
    v_or3_b32 v30, v40, v41, v42
    v_or_b32 v30, v30, v43
    v_cmp_ne_u32_sdwa vcc, v30, v10 src0_sel:BYTE_0 src1_sel:DWORD
    s_cbranch_vccnz L_rty0_2
L_ok0_2:
    s_waitcnt vmcnt(0)
L_chk0_3:
    v_xor_b32 v44, v5, v44
    v_xor_b32 v45, v5, v45
    v_xor_b32 v46, v5, v46
    v_xor_b32 v47, v5, v47
    v_or3_b32 v30, v44, v45, v46
    v_or_b32 v30, v30, v47
    v_cmp_ne_u32_sdwa vcc, v30, v10 src0_sel:BYTE_0 src1_sel:DWORD
    s_cbranch_vccnz L_rty0_3
L_ok0_3:
    v_pk_add_f32 v[40:41], v[40:41], v[44:45]
    v_pk_add_f32 v[42:43], v[42:43], v[46:47]
    v_permlane32_swap_b32 v32, v33
    v_permlane32_swap_b32 v34, v35
    v_permlane32_swap_b32 v40, v41
    v_permlane32_swap_b32 v42, v43
    v_add_f32 v32, v32, v33
    v_add_f32 v34, v34, v35
    v_add_f32 v40, v40, v41
    v_add_f32 v42, v42, v43
    v_permlane16_swap_b32 v32, v34
    s_nop 0
    v_permlane16_swap_b32 v40, v42
    v_add_f32 v32, v32, v34
    v_add_f32 v40, v40, v42
    v_cvt_pk_bf16_f32 v24, v32, v40
    v_lshlrev_b32 v22, 16, v24
    v_and_b32 v23, s41, v24
    v_add_f32 v23, 1.0, v23
    v_cvt_pk_bf16_f32 v23, v23, v23
    v_and_b32 v23, s41, v23
    v_mul_f32 v23, v172, v23
    v_cvt_pk_bf16_f32 v23, v23, v23
    v_and_b32 v23, s41, v23
    v_add_f32 v23, v23, v22
    v_cvt_pk_bf16_f32 v23, v23, v23
    ds_write_b32 v19, v23
    ds_read_b128 v[164:167], v20
    ds_read_b128 v[168:171], v20 offset:16
    s_waitcnt lgkmcnt(0)
    v_and_b32 v64, v164, v14
    v_and_b32 v65, v164, v15
    v_and_b32 v66, v164, v16
    v_and_b32 v67, v164, v17
    v_and_b32 v68, v165, v14
    v_and_b32 v69, v165, v15
    v_and_b32 v70, v165, v16
    v_and_b32 v71, v165, v17
    v_mfma_f32_16x16x32_bf16 v[80:83], v[64:67], v[120:123], 0
    v_and_b32 v72, v166, v14
    v_and_b32 v73, v166, v15
    v_and_b32 v74, v166, v16
    v_and_b32 v75, v166, v17
    v_mfma_f32_16x16x32_bf16 v[80:83], v[68:71], v[124:127], v[80:83]
    v_and_b32 v76, v167, v14
    v_and_b32 v77, v167, v15
    v_and_b32 v78, v167, v16
    v_and_b32 v79, v167, v17
    v_mfma_f32_16x16x32_bf16 v[80:83], v[72:75], v[128:131], v[80:83]
    v_and_b32 v64, v168, v14
    v_and_b32 v65, v168, v15
    v_and_b32 v66, v168, v16
    v_and_b32 v67, v168, v17
    v_mfma_f32_16x16x32_bf16 v[80:83], v[76:79], v[132:135], v[80:83]
    v_and_b32 v68, v169, v14
    v_and_b32 v69, v169, v15
    v_and_b32 v70, v169, v16
    v_and_b32 v71, v169, v17
    v_mfma_f32_16x16x32_bf16 v[80:83], v[64:67], v[136:139], v[80:83]
    v_and_b32 v72, v170, v14
    v_and_b32 v73, v170, v15
    v_and_b32 v74, v170, v16
    v_and_b32 v75, v170, v17
    v_mfma_f32_16x16x32_bf16 v[80:83], v[68:71], v[140:143], v[80:83]
    v_and_b32 v76, v171, v14
    v_and_b32 v77, v171, v15
    v_and_b32 v78, v171, v16
    v_and_b32 v79, v171, v17
    v_mfma_f32_16x16x32_bf16 v[80:83], v[72:75], v[144:147], v[80:83]
    s_nop 0
    v_mfma_f32_16x16x32_bf16 v[80:83], v[76:79], v[148:151], v[80:83]
    s_mov_b64 exec, s[46:47]
    s_nop 6
    ds_write_b128 v18, v[80:83] offset:2048
    s_mov_b64 exec, -1
    s_cmp_lg_u32 s34, 0
    s_waitcnt lgkmcnt(0)
    s_barrier
    s_cbranch_scc1 L_trskip1
    ds_read2st64_b32 v[32:33], v12 offset0:8 offset1:9
    ds_read2st64_b32 v[34:35], v12 offset0:10 offset1:11
    ds_read2st64_b32 v[36:37], v12 offset0:12 offset1:13
    ds_read2st64_b32 v[38:39], v12 offset0:14 offset1:15
    s_waitcnt lgkmcnt(2)
    v_pk_add_f32 v[32:33], v[32:33], v[34:35]
    s_waitcnt lgkmcnt(0)
    v_pk_add_f32 v[36:37], v[36:37], v[38:39]
    v_pk_add_f32 v[32:33], v[32:33], v[36:37]
    v_add_f32 v32, v32, v33
    v_bfi_b32 v32, s42, v5, v32
    s_nop 1
    v_mov_b32_dpp v40, v32 quad_perm:[0,0,0,0] row_mask:0xf bank_mask:0xf
    v_mov_b32_dpp v41, v32 quad_perm:[1,1,1,1] row_mask:0xf bank_mask:0xf
    v_mov_b32_dpp v42, v32 quad_perm:[2,2,2,2] row_mask:0xf bank_mask:0xf
    v_mov_b32_dpp v43, v32 quad_perm:[3,3,3,3] row_mask:0xf bank_mask:0xf
    s_mov_b64 exec, s[62:63]
    global_store_dwordx4 v175, v[40:43], s[60:61] offset:0
    global_store_dwordx4 v175, v[40:43], s[30:31] offset:0 sc1
    s_mov_b64 exec, -1
L_trskip1:
    s_barrier
    global_load_dwordx4 v[84:87], v119, s[24:25] nt
    v_add_u32 v119, 6144, v119
    global_load_dwordx4 v[88:91], v119, s[24:25] nt
    v_add_u32 v119, 6144, v119
    global_load_dwordx4 v[92:95], v119, s[24:25] nt
    v_add_u32 v119, 6144, v119
    global_load_dwordx4 v[96:99], v119, s[24:25] nt
    global_load_dwordx4 v[100:103], v29, s[12:13] nt
    v_add_u32 v29, 8192, v29
    global_load_dwordx4 v[100:103], v29, s[12:13] nt
    v_add_u32 v29, 8192, v29
    global_load_dwordx4 v[100:103], v29, s[12:13] nt
    v_add_u32 v29, 8192, v29
    global_load_dwordx4 v[100:103], v29, s[12:13] nt
    v_add_u32 v29, 8192, v29
    global_load_dwordx4 v[100:103], v29, s[12:13] nt
    v_add_u32 v29, 8192, v29
    global_load_dwordx4 v[100:103], v29, s[12:13] nt
    v_add_u32 v29, 8192, v29
    global_load_dwordx4 v[100:103], v29, s[12:13] nt
    v_add_u32 v29, 8192, v29
    global_load_dwordx4 v[100:103], v29, s[12:13] nt
    s_lshl_b32 s35, s32, 2
    s_mul_i32 s36, s32, 3
    s_add_u32 s36, s36, 4
    s_cmp_ge_u32 s32, 4
    s_cselect_b32 s35, s36, s35
    s_cselect_b32 s37, 12, 16
    s_lshl_b32 s43, s35, 2
    s_add_u32 s43, s43, s44
    s_cmp_ge_u32 s44, s37
    s_cselect_b32 s45, 1, 0
    s_and_b32 s35, s43, 3
    s_lshl_b32 s35, s35, 7
    s_lshl_b32 s38, s34, 5
    s_add_u32 s35, s35, s38
    v_add_u32 v22, s35, v2
    s_lshr_b32 s36, s43, 2
    s_lshl_b32 s36, s36, 7
    v_mul_u32_u24 v217, 3584, v22
    v_lshl_add_u32 v217, v3, 4, v217
    v_add_u32 v217, s36, v217
    s_lshl_b32 s36, s43, 14
    s_lshl_b32 s38, s34, 8
    s_add_u32 s36, s36, s38
    v_lshlrev_b32 v218, 10, v8
    v_lshl_add_u32 v218, v9, 4, v218
    v_add_u32 v218, s36, v218
    s_lshl_b32 s36, s43, 11
    s_add_u32 s36, s36, 425984
    v_lshlrev_b32 v232, 9, v8
    v_lshl_add_u32 v232, v9, 4, v232
    v_add_u32 v232, s36, v232
    v_lshlrev_b32 v22, 16, v116
    v_and_b32 v23, s41, v116
    v_lshlrev_b32 v24, 16, v117
    v_and_b32 v25, s41, v117
    v_mul_f32 v26, s40, v22
    v_mul_f32 v27, s40, v23
    v_mul_f32 v28, s40, v24
    v_mul_f32 v29, s40, v25
    v_exp_f32 v26, -v26
    v_exp_f32 v27, -v27
    v_exp_f32 v28, -v28
    v_exp_f32 v29, -v29
    v_add_f32 v26, 1.0, v26
    v_add_f32 v27, 1.0, v27
    v_add_f32 v28, 1.0, v28
    v_add_f32 v29, 1.0, v29
    v_rcp_f32 v26, v26
    v_rcp_f32 v27, v27
    v_rcp_f32 v28, v28
    v_rcp_f32 v29, v29
    v_mul_f32 v26, v22, v26
    v_mul_f32 v27, v23, v27
    v_mul_f32 v28, v24, v28
    v_mul_f32 v29, v25, v29
    v_cvt_pk_bf16_f32 v200, v26, v26
    v_cvt_pk_bf16_f32 v201, v27, v27
    v_cvt_pk_bf16_f32 v202, v28, v28
    v_cvt_pk_bf16_f32 v203, v29, v29
    s_lshl_b32 s35, s32, 12
    s_lshl_b32 s38, s44, 8
    s_add_u32 s35, s35, s38
    s_add_u32 s35, s35, 655360
    v_add_u32 v219, s35, v12
    s_waitcnt vmcnt(8)
    v_and_b32 v64, v200, v14
    v_and_b32 v65, v200, v15
    v_and_b32 v66, v200, v16
    v_and_b32 v67, v200, v17
    v_and_b32 v68, v201, v14
    v_and_b32 v69, v201, v15
    v_and_b32 v70, v201, v16
    v_and_b32 v71, v201, v17
    v_mfma_f32_16x16x32_bf16 v[80:83], v[64:67], v[84:87], 0
    v_and_b32 v72, v202, v14
    v_and_b32 v73, v202, v15
    v_and_b32 v74, v202, v16
    v_and_b32 v75, v202, v17
    v_mfma_f32_16x16x32_bf16 v[80:83], v[68:71], v[88:91], v[80:83]
    v_and_b32 v76, v203, v14
    v_and_b32 v77, v203, v15
    v_and_b32 v78, v203, v16
    v_and_b32 v79, v203, v17
    v_mfma_f32_16x16x32_bf16 v[80:83], v[72:75], v[92:95], v[80:83]
    s_nop 0
    v_mfma_f32_16x16x32_bf16 v[80:83], v[76:79], v[96:99], v[80:83]
    s_mov_b64 exec, s[46:47]
    s_nop 6
    ds_write_b128 v18, v[80:83] offset:0
    s_mov_b64 exec, -1
    s_cmp_lg_u32 s34, 0
    s_waitcnt lgkmcnt(0)
    s_barrier
    s_cbranch_scc1 L_trskip2
    ds_read2st64_b32 v[32:33], v12 offset0:0 offset1:1
    ds_read2st64_b32 v[34:35], v12 offset0:2 offset1:3
    ds_read2st64_b32 v[36:37], v12 offset0:4 offset1:5
    ds_read2st64_b32 v[38:39], v12 offset0:6 offset1:7
    s_waitcnt lgkmcnt(2)
    v_pk_add_f32 v[32:33], v[32:33], v[34:35]
    s_waitcnt lgkmcnt(0)
    v_pk_add_f32 v[36:37], v[36:37], v[38:39]
    v_pk_add_f32 v[32:33], v[32:33], v[36:37]
    v_add_f32 v32, v32, v33
    v_bfi_b32 v32, s42, v5, v32
    s_nop 1
    v_mov_b32_dpp v40, v32 quad_perm:[0,0,0,0] row_mask:0xf bank_mask:0xf
    v_mov_b32_dpp v41, v32 quad_perm:[1,1,1,1] row_mask:0xf bank_mask:0xf
    v_mov_b32_dpp v42, v32 quad_perm:[2,2,2,2] row_mask:0xf bank_mask:0xf
    v_mov_b32_dpp v43, v32 quad_perm:[3,3,3,3] row_mask:0xf bank_mask:0xf
    s_mov_b64 exec, s[62:63]
    global_store_dwordx4 v219, v[40:43], s[30:31] offset:0 sc1
    s_mov_b64 exec, -1
L_trskip2:
    s_cmp_lg_u32 s45, 0
    s_barrier
    s_cbranch_scc1 L_COMB
    global_load_dwordx4 v[120:123], v217, s[16:17] nt
    global_load_dwordx4 v[136:139], v217, s[18:19] nt
    v_add_u32 v217, 28672, v217
    global_load_dwordx4 v[124:127], v217, s[16:17] nt
    global_load_dwordx4 v[140:143], v217, s[18:19] nt
    v_add_u32 v217, 28672, v217
    global_load_dwordx4 v[128:131], v217, s[16:17] nt
    global_load_dwordx4 v[144:147], v217, s[18:19] nt
    v_add_u32 v217, 28672, v217
    global_load_dwordx4 v[132:135], v217, s[16:17] nt
    global_load_dwordx4 v[148:151], v217, s[18:19] nt
    global_load_dwordx4 v[152:155], v218, s[20:21] nt
    v_add_u32 v218, 4096, v218
    global_load_dwordx4 v[156:159], v218, s[20:21] nt
    v_add_u32 v218, 4096, v218
    global_load_dwordx4 v[160:163], v218, s[20:21] nt
    v_add_u32 v218, 4096, v218
    global_load_dwordx4 v[164:167], v218, s[20:21] nt
    global_load_dword v11, v232, s[60:61]
    global_load_dword v11, v232, s[60:61] offset:256
    s_lshl_b32 s38, s34, 5
    v_lshl_add_u32 v27, v3, 2, v7
    v_add_u32 v27, s38, v27
    v_lshlrev_b32 v226, 1, v27
    s_and_b32 s35, s43, 3
    s_lshr_b32 s36, s34, 1
    s_and_b32 s37, s34, 1
    s_lshl_b32 s36, s36, 10
    s_lshl_b32 s38, s35, 11
    s_add_u32 s36, s36, s38
    s_lshl_b32 s38, s37, 7
    s_add_u32 s36, s36, s38
    s_add_u32 s36, s36, 655360
    v_lshlrev_b32 v222, 4, v3
    v_lshl_add_u32 v222, v7, 2, v222
    v_add_u32 v222, s36, v222
    v_add_u32 v236, 8192, v222
    v_add_u32 v237, 16384, v222
    s_lshl_b32 s36, s35, 9
    s_lshl_b32 s38, s34, 7
    s_add_u32 s36, s36, s38
    s_add_u32 s36, s36, 688128
    v_mul_u32_u24 v220, 2176, v2
    v_lshl_add_u32 v220, v3, 4, v220
    v_add_u32 v220, s36, v220
    v_add_u32 v221, 17408, v220
    v_and_b32 v22, 3, v1
    v_lshlrev_b32 v229, 3, v22
    v_lshlrev_b32 v227, 8, v22
    v_lshl_add_u32 v227, v8, 4, v227
    s_lshl_b32 s38, s34, 3
    v_mov_b32 v230, s38
    s_andn2_b32 s36, s43, 3
    s_lshl_b32 s36, s36, 11
    s_lshl_b32 s38, s34, 11
    s_add_u32 s36, s36, s38
    s_lshl_b32 s38, s35, 9
    s_add_u32 s36, s36, s38
    s_add_u32 s36, s36, 425984
    v_lshl_add_u32 v231, v1, 2, s36
    s_mul_i32 s36, s43, 2176
    s_lshl_b32 s38, s34, 9
    s_add_u32 s36, s36, s38
    s_add_u32 s36, s36, 737280
    v_lshl_add_u32 v228, v1, 2, s36
    s_lshl_b32 s37, s34, 12
    v_add_u32 v225, s37, v4
    v_bfe_u32 v23, v1, 2, 2
    s_lshl_b32 s36, s34, 5
    v_lshlrev_b32 v223, 7, v23
    v_lshl_add_u32 v223, v8, 10, v223
    v_lshl_add_u32 v223, v22, 3, v223
    v_add_u32 v223, s36, v223
    v_lshlrev_b32 v224, 10, v23
    v_lshl_add_u32 v224, v7, 8, v224
    v_lshl_add_u32 v224, v22, 3, v224
    v_add_u32 v224, s37, v224
    v_cmp_eq_u32 vcc, 0, v23
    s_nop 1
    v_cndmask_b32 v233, 0, 1.0, vcc
    v_cmp_eq_u32 vcc, 1, v23
    s_nop 1
    v_cndmask_b32 v234, 0, 1.0, vcc
    v_cmp_eq_u32 vcc, 2, v23
    s_nop 1
    v_cndmask_b32 v235, 0, 1.0, vcc
    s_mov_b32 s48, 0xffff0000
    s_mov_b32 s49, 0
    s_mov_b32 s50, 0
    s_mov_b32 s51, 0x0000ffff
    s_mov_b32 s52, 0
    s_mov_b32 s53, 0xffff0000
    s_mov_b32 s58, 0xf000f000
    s_mov_b32 s59, 0xf000f000
    s_mov_b32 s56, 0
    s_mov_b32 s57, 0x80000000
    s_mov_b32 s39, 20000
    global_load_dword v32, v222, s[30:31] offset:0 sc1
    global_load_dword v33, v222, s[30:31] offset:256 sc1
    global_load_dword v34, v222, s[30:31] offset:512 sc1
    global_load_dword v35, v222, s[30:31] offset:768 sc1
    global_load_dword v36, v236, s[30:31] offset:0 sc1
    global_load_dword v37, v236, s[30:31] offset:256 sc1
    global_load_dword v38, v236, s[30:31] offset:512 sc1
    global_load_dword v39, v236, s[30:31] offset:768 sc1
    global_load_dword v40, v237, s[30:31] offset:0 sc1
    global_load_dword v41, v237, s[30:31] offset:256 sc1
    global_load_dword v42, v237, s[30:31] offset:512 sc1
    global_load_dword v43, v237, s[30:31] offset:768 sc1
    s_waitcnt vmcnt(25)
    ds_write_b128 v225, v[120:123] offset:8448
    s_waitcnt vmcnt(24)
    ds_write_b128 v225, v[136:139] offset:24832
    s_waitcnt vmcnt(23)
    ds_write_b128 v225, v[124:127] offset:9472
    s_waitcnt vmcnt(22)
    ds_write_b128 v225, v[140:143] offset:25856
    s_waitcnt vmcnt(21)
    ds_write_b128 v225, v[128:131] offset:10496
    s_waitcnt vmcnt(20)
    ds_write_b128 v225, v[144:147] offset:26880
    s_waitcnt vmcnt(19)
    ds_write_b128 v225, v[132:135] offset:11520
    s_waitcnt vmcnt(18)
    ds_write_b128 v225, v[148:151] offset:27904
    s_waitcnt vmcnt(17)
    ds_write_b128 v225, v[152:155] offset:41216
    s_waitcnt vmcnt(16)
    ds_write_b128 v225, v[156:159] offset:42240
    s_waitcnt vmcnt(15)
    ds_write_b128 v225, v[160:163] offset:43264
    s_waitcnt vmcnt(14)
    ds_write_b128 v225, v[164:167] offset:44288
    ds_read_b64_tr_b16 v[100:101], v224 offset:41216
    ds_read_b64_tr_b16 v[102:103], v224 offset:41248
    ds_read_b64_tr_b16 v[104:105], v224 offset:41280
    ds_read_b64_tr_b16 v[106:107], v224 offset:41312
    ds_read_b64_tr_b16 v[108:109], v224 offset:41344
    ds_read_b64_tr_b16 v[110:111], v224 offset:41376
    ds_read_b64_tr_b16 v[112:113], v224 offset:41408
    ds_read_b64_tr_b16 v[114:115], v224 offset:41440
    s_waitcnt lgkmcnt(0)
    s_barrier
    ds_read_b64_tr_b16 v[168:169], v223 offset:8448
    ds_read_b64_tr_b16 v[170:171], v223 offset:8960
    ds_read_b64_tr_b16 v[172:173], v223 offset:12544
    ds_read_b64_tr_b16 v[174:175], v223 offset:13056
    ds_read_b64_tr_b16 v[176:177], v223 offset:16640
    ds_read_b64_tr_b16 v[178:179], v223 offset:17152
    ds_read_b64_tr_b16 v[180:181], v223 offset:20736
    ds_read_b64_tr_b16 v[182:183], v223 offset:21248
    ds_read_b64_tr_b16 v[184:185], v223 offset:24832
    ds_read_b64_tr_b16 v[186:187], v223 offset:25344
    ds_read_b64_tr_b16 v[188:189], v223 offset:28928
    ds_read_b64_tr_b16 v[190:191], v223 offset:29440
    ds_read_b64_tr_b16 v[192:193], v223 offset:33024
    ds_read_b64_tr_b16 v[194:195], v223 offset:33536
    ds_read_b64_tr_b16 v[196:197], v223 offset:37120
    ds_read_b64_tr_b16 v[198:199], v223 offset:37632
    s_waitcnt vmcnt(11)
L_chk1_0:
    v_xor_b32 v32, v5, v32
    v_cmp_ne_u32_sdwa vcc, v32, v10 src0_sel:BYTE_0 src1_sel:DWORD
    s_cbranch_vccnz L_rty1_0
L_ok1_0:
    s_waitcnt vmcnt(10)
L_chk1_1:
    v_xor_b32 v33, v5, v33
    v_cmp_ne_u32_sdwa vcc, v33, v10 src0_sel:BYTE_0 src1_sel:DWORD
    s_cbranch_vccnz L_rty1_1
L_ok1_1:
    s_waitcnt vmcnt(9)
L_chk1_2:
    v_xor_b32 v34, v5, v34
    v_cmp_ne_u32_sdwa vcc, v34, v10 src0_sel:BYTE_0 src1_sel:DWORD
    s_cbranch_vccnz L_rty1_2
L_ok1_2:
    s_waitcnt vmcnt(8)
L_chk1_3:
    v_xor_b32 v35, v5, v35
    v_cmp_ne_u32_sdwa vcc, v35, v10 src0_sel:BYTE_0 src1_sel:DWORD
    s_cbranch_vccnz L_rty1_3
L_ok1_3:
    v_pk_add_f32 v[32:33], v[32:33], v[34:35]
    v_add_f32 v32, v32, v33
    v_cvt_pk_bf16_f32 v214, v32, v32
    v_and_b32 v214, s41, v214
    s_waitcnt vmcnt(7)
L_chk1_4:
    v_xor_b32 v36, v5, v36
    v_cmp_ne_u32_sdwa vcc, v36, v10 src0_sel:BYTE_0 src1_sel:DWORD
    s_cbranch_vccnz L_rty1_4
L_ok1_4:
    s_waitcnt vmcnt(6)
L_chk1_5:
    v_xor_b32 v37, v5, v37
    v_cmp_ne_u32_sdwa vcc, v37, v10 src0_sel:BYTE_0 src1_sel:DWORD
    s_cbranch_vccnz L_rty1_5
L_ok1_5:
    s_waitcnt vmcnt(5)
L_chk1_6:
    v_xor_b32 v38, v5, v38
    v_cmp_ne_u32_sdwa vcc, v38, v10 src0_sel:BYTE_0 src1_sel:DWORD
    s_cbranch_vccnz L_rty1_6
L_ok1_6:
    s_waitcnt vmcnt(4)
L_chk1_7:
    v_xor_b32 v39, v5, v39
    v_cmp_ne_u32_sdwa vcc, v39, v10 src0_sel:BYTE_0 src1_sel:DWORD
    s_cbranch_vccnz L_rty1_7
L_ok1_7:
    v_pk_add_f32 v[36:37], v[36:37], v[38:39]
    v_add_f32 v36, v36, v37
    v_cvt_pk_bf16_f32 v215, v36, v36
    v_and_b32 v215, s41, v215
    s_waitcnt vmcnt(3)
L_chk1_8:
    v_xor_b32 v40, v5, v40
    v_cmp_ne_u32_sdwa vcc, v40, v10 src0_sel:BYTE_0 src1_sel:DWORD
    s_cbranch_vccnz L_rty1_8
L_ok1_8:
    s_waitcnt vmcnt(2)
L_chk1_9:
    v_xor_b32 v41, v5, v41
    v_cmp_ne_u32_sdwa vcc, v41, v10 src0_sel:BYTE_0 src1_sel:DWORD
    s_cbranch_vccnz L_rty1_9
L_ok1_9:
    s_waitcnt vmcnt(1)
L_chk1_10:
    v_xor_b32 v42, v5, v42
    v_cmp_ne_u32_sdwa vcc, v42, v10 src0_sel:BYTE_0 src1_sel:DWORD
    s_cbranch_vccnz L_rty1_10
L_ok1_10:
    s_waitcnt vmcnt(0)
L_chk1_11:
    v_xor_b32 v43, v5, v43
    v_cmp_ne_u32_sdwa vcc, v43, v10 src0_sel:BYTE_0 src1_sel:DWORD
    s_cbranch_vccnz L_rty1_11
L_ok1_11:
    v_pk_add_f32 v[40:41], v[40:41], v[42:43]
    v_add_f32 v40, v40, v41
    v_cvt_pk_bf16_f32 v216, v40, v40
    v_and_b32 v216, s41, v216
    v_add_f32 v216, 1.0, v216
    v_cvt_pk_bf16_f32 v216, v216, v216
    v_and_b32 v216, s41, v216
    ds_write_b16_d16_hi v226, v216 offset:7424
    ds_write_b16_d16_hi v226, v215 offset:7680
    s_mov_b32 s39, 20000
    global_load_dwordx4 v[32:35], v220, s[30:31] offset:0 sc1
    global_load_dwordx4 v[36:39], v221, s[30:31] offset:0 sc1
    s_waitcnt vmcnt(1)
L_chk2_0:
    v_xor_b32 v32, v5, v32
    v_xor_b32 v33, v5, v33
    v_xor_b32 v34, v5, v34
    v_xor_b32 v35, v5, v35
    v_or3_b32 v30, v32, v33, v34
    v_or_b32 v30, v30, v35
    v_cmp_ne_u32_sdwa vcc, v30, v10 src0_sel:BYTE_0 src1_sel:DWORD
    s_cbranch_vccnz L_rty2_0
L_ok2_0:
    s_waitcnt vmcnt(0)
L_chk2_1:
    v_xor_b32 v36, v5, v36
    v_xor_b32 v37, v5, v37
    v_xor_b32 v38, v5, v38
    v_xor_b32 v39, v5, v39
    v_or3_b32 v30, v36, v37, v38
    v_or_b32 v30, v30, v39
    v_cmp_ne_u32_sdwa vcc, v30, v10 src0_sel:BYTE_0 src1_sel:DWORD
    s_cbranch_vccnz L_rty2_1
L_ok2_1:
    v_pk_add_f32 v[32:33], v[32:33], v[36:37]
    v_pk_add_f32 v[34:35], v[34:35], v[38:39]
    s_nop 0
    v_permlane32_swap_b32 v32, v33
    v_permlane32_swap_b32 v34, v35
    v_add_f32 v32, v32, v33
    v_add_f32 v34, v34, v35
    s_nop 1
    v_permlane16_swap_b32 v32, v34
    v_add_f32 v32, v32, v34
    s_nop 1
    v_add_f32_dpp v32, v32, v32 row_ror:8 row_mask:0xf bank_mask:0xf
    v_cvt_pk_bf16_f32 v32, v32, v32
    v_and_b32 v32, s41, v32
    v_mul_f32 v32, v214, v32
    v_cvt_pk_bf16_f32 v32, v32, v32
    v_and_b32 v32, s41, v32
    v_add_f32 v32, v118, v32
    v_cvt_pk_bf16_f32 v118, v32, v32
    v_and_b32 v118, s41, v118
    v_mul_f32 v24, v118, v216
    v_readfirstlane_b32 s35, v118
    v_cvt_pk_bf16_f32 v25, v24, v24
    v_and_b32 v26, s41, v25
    v_subrev_f32 v22, s35, v118
    v_sub_f32 v24, v24, v26
    v_mul_f32 v23, v22, v22
    ds_write_b16 v226, v25 offset:6912
    ds_write_b16_d16_hi v226, v24 offset:7168
    v_add_f32_dpp v22, v22, v22 quad_perm:[1,0,3,2] row_mask:0xf bank_mask:0xf
    v_add_f32_dpp v23, v23, v23 quad_perm:[1,0,3,2] row_mask:0xf bank_mask:0xf
    s_nop 0
    v_add_f32_dpp v22, v22, v22 quad_perm:[2,3,0,1] row_mask:0xf bank_mask:0xf
    v_add_f32_dpp v23, v23, v23 quad_perm:[2,3,0,1] row_mask:0xf bank_mask:0xf
    s_nop 0
    v_add_f32_dpp v22, v22, v22 row_half_mirror row_mask:0xf bank_mask:0xf
    v_add_f32_dpp v23, v23, v23 row_half_mirror row_mask:0xf bank_mask:0xf
    s_nop 0
    v_add_f32_dpp v22, v22, v22 row_mirror row_mask:0xf bank_mask:0xf
    v_add_f32_dpp v23, v23, v23 row_mirror row_mask:0xf bank_mask:0xf
    s_nop 0
    v_add_f32_dpp v22, v22, v22 row_bcast:15 row_mask:0xa bank_mask:0xf
    v_add_f32_dpp v23, v23, v23 row_bcast:15 row_mask:0xa bank_mask:0xf
    s_nop 0
    v_add_f32_dpp v22, v22, v22 row_bcast:31 row_mask:0xc bank_mask:0xf
    v_add_f32_dpp v23, v23, v23 row_bcast:31 row_mask:0xc bank_mask:0xf
    v_mul_f32 v24, 0x3c800000, v22
    v_add_f32 v32, s35, v24
    v_fma_f32 v33, -v24, v22, v23
    s_mov_b64 exec, s[56:57]
    ds_write_b64 v230, v[32:33] offset:6784
    s_mov_b64 exec, -1
    s_waitcnt lgkmcnt(0)
    s_barrier
    ds_read_b64 v[32:33], v229 offset:6784
    ds_read_b128 v[64:67], v227 offset:6912
    ds_read_b128 v[68:71], v227 offset:6976
    ds_read_b128 v[72:75], v227 offset:7040
    ds_read_b128 v[76:79], v227 offset:7104
    s_waitcnt lgkmcnt(3)
    v_mfma_f32_16x16x32_bf16 v[204:207], v[64:67], v[168:171], 0
    v_mfma_f32_16x16x32_bf16 v[208:211], v[64:67], v[184:187], 0
    v_add_f32_dpp v22, v32, v32 quad_perm:[1,0,3,2] row_mask:0xf bank_mask:0xf
    s_waitcnt lgkmcnt(2)
    v_mfma_f32_16x16x32_bf16 v[204:207], v[68:71], v[172:175], v[204:207]
    v_mfma_f32_16x16x32_bf16 v[208:211], v[68:71], v[188:191], v[208:211]
    v_add_f32_dpp v22, v22, v22 quad_perm:[2,3,0,1] row_mask:0xf bank_mask:0xf
    v_mul_f32 v212, 0x3e800000, v22
    s_waitcnt lgkmcnt(1)
    v_mfma_f32_16x16x32_bf16 v[204:207], v[72:75], v[176:179], v[204:207]
    v_mfma_f32_16x16x32_bf16 v[208:211], v[72:75], v[192:195], v[208:211]
    v_sub_f32 v23, v32, v212
    v_mul_f32 v24, 0x42800000, v23
    v_fmac_f32 v33, v23, v24
    s_waitcnt lgkmcnt(0)
    v_mfma_f32_16x16x32_bf16 v[204:207], v[76:79], v[180:183], v[204:207]
    v_mfma_f32_16x16x32_bf16 v[208:211], v[76:79], v[196:199], v[208:211]
    v_add_f32_dpp v33, v33, v33 quad_perm:[1,0,3,2] row_mask:0xf bank_mask:0xf
    v_and_b32 v25, 1, v1
    v_cmp_eq_u32 vcc, 1, v25
    v_add_f32_dpp v33, v33, v33 quad_perm:[2,3,0,1] row_mask:0xf bank_mask:0xf
    v_mul_f32 v213, 0.5, v33
    v_cndmask_b32 v25, v212, v213, vcc
    s_nop 0
    v_add_f32 v204, v204, v205
    v_cndmask_b32 v205, v204, v206, s[48:49]
    v_cndmask_b32 v205, v205, v207, s[50:51]
    v_cndmask_b32 v205, v205, v25, s[52:53]
    v_bfi_b32 v205, s42, v5, v205
    global_store_dword v231, v205, s[60:61] offset:0
    v_add_f32 v208, v208, v209
    v_cndmask_b32 v209, v208, v210, s[48:49]
    v_cndmask_b32 v209, v209, v211, s[50:51]
    v_cndmask_b32 v209, v209, v25, s[52:53]
    v_bfi_b32 v209, s42, v5, v209
    global_store_dword v231, v209, s[60:61] offset:256
    s_mov_b32 s39, 20000
    global_load_dwordx4 v[32:35], v232, s[60:61] offset:0 sc1
    global_load_dwordx4 v[36:39], v232, s[60:61] offset:256 sc1
    s_waitcnt vmcnt(1)
L_chk3_0:
    v_xor_b32 v32, v5, v32
    v_xor_b32 v33, v5, v33
    v_xor_b32 v34, v5, v34
    v_xor_b32 v35, v5, v35
    v_or3_b32 v30, v32, v33, v34
    v_or_b32 v30, v30, v35
    v_cmp_ne_u32_sdwa vcc, v30, v10 src0_sel:BYTE_0 src1_sel:DWORD
    s_cbranch_vccnz L_rty3_0
L_ok3_0:
    s_mov_b64 exec, s[58:59]
    v_sub_f32 v32, v32, v212
    v_mul_f32 v22, 0x43000000, v32
    v_fmac_f32 v33, v22, v32
    s_mov_b64 exec, -1
    s_waitcnt vmcnt(0)
L_chk3_1:
    v_xor_b32 v36, v5, v36
    v_xor_b32 v37, v5, v37
    v_xor_b32 v38, v5, v38
    v_xor_b32 v39, v5, v39
    v_or3_b32 v30, v36, v37, v38
    v_or_b32 v30, v30, v39
    v_cmp_ne_u32_sdwa vcc, v30, v10 src0_sel:BYTE_0 src1_sel:DWORD
    s_cbranch_vccnz L_rty3_1
L_ok3_1:
    v_permlane32_swap_b32 v32, v33
    v_permlane32_swap_b32 v34, v35
    v_permlane32_swap_b32 v36, v37
    v_permlane32_swap_b32 v38, v39
    v_add_f32 v32, v32, v33
    v_add_f32 v34, v34, v35
    v_add_f32 v36, v36, v37
    v_add_f32 v38, v38, v39
    v_permlane16_swap_b32 v32, v34
    s_nop 0
    v_permlane16_swap_b32 v36, v38
    v_add_f32 v32, v32, v34
    v_add_f32 v36, v36, v38
    v_readlane_b32 s35, v32, 12
    v_readlane_b32 s36, v32, 44
    s_nop 0
    v_mov_b32 v22, s35
    v_mul_f32 v23, 0xc2000000, v22
    v_fma_f32 v24, v23, v22, s36
    v_mul_f32 v24, 0x3b000000, v24
    v_fmac_f32 v212, 0x3e800000, v22
    v_cvt_pk_bf16_f32 v24, v24, v24
    v_and_b32 v24, s41, v24
    v_add_f32 v24, 0x3727c5ac, v24
    v_cvt_pk_bf16_f32 v24, v24, v24
    v_and_b32 v24, s41, v24
    v_sqrt_f32 v24, v24
    v_cvt_pk_bf16_f32 v212, v212, v212
    v_and_b32 v212, s41, v212
    v_cvt_pk_bf16_f32 v24, v24, v24
    v_and_b32 v24, s41, v24
    v_rcp_f32 v24, v24
    v_fma_f32 v25, -v212, v234, v233
    v_fma_f32 v25, v25, v24, v235
    v_mul_f32 v32, v32, v25
    v_mul_f32 v36, v36, v25
    s_nop 0
    v_add_f32_dpp v32, v32, v32 row_ror:4 row_mask:0xf bank_mask:0xf
    v_add_f32_dpp v36, v36, v36 row_ror:4 row_mask:0xf bank_mask:0xf
    s_nop 0
    v_add_f32_dpp v32, v32, v32 row_ror:8 row_mask:0xf bank_mask:0xf
    v_add_f32_dpp v36, v36, v36 row_ror:8 row_mask:0xf bank_mask:0xf
    v_cvt_pk_bf16_f32 v24, v32, v36
    v_lshlrev_b32 v22, 16, v24
    v_and_b32 v23, s41, v24
    v_mul_f32 v22, v22, v23
    s_nop 1
    v_mov_b32_dpp v32, v22 quad_perm:[0,0,0,0] row_mask:0xf bank_mask:0xf
    v_mov_b32_dpp v33, v22 quad_perm:[1,1,1,1] row_mask:0xf bank_mask:0xf
    v_mov_b32_dpp v34, v22 quad_perm:[2,2,2,2] row_mask:0xf bank_mask:0xf
    v_mov_b32_dpp v35, v22 quad_perm:[3,3,3,3] row_mask:0xf bank_mask:0xf
    v_cvt_pk_bf16_f32 v64, v32, v33
    v_cvt_pk_bf16_f32 v65, v34, v35
    s_nop 1
    v_mfma_f32_16x16x16_bf16 v[120:123], v[64:65], v[100:101], 0
    v_mfma_f32_16x16x16_bf16 v[124:127], v[64:65], v[102:103], 0
    v_mfma_f32_16x16x16_bf16 v[128:131], v[64:65], v[104:105], 0
    v_mfma_f32_16x16x16_bf16 v[132:135], v[64:65], v[106:107], 0
    v_mfma_f32_16x16x16_bf16 v[136:139], v[64:65], v[108:109], 0
    v_mfma_f32_16x16x16_bf16 v[140:143], v[64:65], v[110:111], 0
    v_mfma_f32_16x16x16_bf16 v[144:147], v[64:65], v[112:113], 0
    v_mfma_f32_16x16x16_bf16 v[148:151], v[64:65], v[114:115], 0
    s_nop 1
    v_cndmask_b32 v22, v120, v124, s[48:49]
    v_cndmask_b32 v22, v22, v128, s[50:51]
    v_cndmask_b32 v22, v22, v132, s[52:53]
    v_bfi_b32 v22, s42, v5, v22
    s_nop 1
    v_mov_b32_dpp v32, v22 quad_perm:[0,0,0,0] row_mask:0xf bank_mask:0xf
    v_mov_b32_dpp v33, v22 quad_perm:[1,1,1,1] row_mask:0xf bank_mask:0xf
    v_mov_b32_dpp v34, v22 quad_perm:[2,2,2,2] row_mask:0xf bank_mask:0xf
    v_mov_b32_dpp v35, v22 quad_perm:[3,3,3,3] row_mask:0xf bank_mask:0xf
    s_mov_b64 exec, s[62:63]
    global_store_dwordx4 v228, v[32:35], s[30:31] offset:0 sc1
    s_mov_b64 exec, -1
    v_cndmask_b32 v23, v136, v140, s[48:49]
    v_cndmask_b32 v23, v23, v144, s[50:51]
    v_cndmask_b32 v23, v23, v148, s[52:53]
    v_bfi_b32 v23, s42, v5, v23
    s_nop 1
    v_mov_b32_dpp v36, v23 quad_perm:[0,0,0,0] row_mask:0xf bank_mask:0xf
    v_mov_b32_dpp v37, v23 quad_perm:[1,1,1,1] row_mask:0xf bank_mask:0xf
    v_mov_b32_dpp v38, v23 quad_perm:[2,2,2,2] row_mask:0xf bank_mask:0xf
    v_mov_b32_dpp v39, v23 quad_perm:[3,3,3,3] row_mask:0xf bank_mask:0xf
    s_mov_b64 exec, s[62:63]
    global_store_dwordx4 v228, v[36:39], s[30:31] offset:256 sc1
    s_mov_b64 exec, -1
    global_store_dword v231, v205, s[30:31] sc1
    global_store_dword v231, v209, s[30:31] offset:256 sc1
    s_endpgm
L_rty0_0:
    s_cmp_eq_u32 s39, 0
    s_cbranch_scc1 L_ok0_0
    s_sub_u32 s39, s39, 1
    global_load_dwordx4 v[32:35], v164, s[30:31] offset:0 sc1
    global_load_dwordx4 v[36:39], v164, s[30:31] offset:1024 sc1
    global_load_dwordx4 v[40:43], v165, s[30:31] offset:0 sc1
    global_load_dwordx4 v[44:47], v165, s[30:31] offset:1024 sc1
    s_waitcnt vmcnt(3)
    s_branch L_chk0_0
L_rty0_1:
    s_cmp_eq_u32 s39, 0
    s_cbranch_scc1 L_ok0_1
    s_sub_u32 s39, s39, 1
    global_load_dwordx4 v[36:39], v164, s[30:31] offset:1024 sc1
    global_load_dwordx4 v[40:43], v165, s[30:31] offset:0 sc1
    global_load_dwordx4 v[44:47], v165, s[30:31] offset:1024 sc1
    s_waitcnt vmcnt(2)
    s_branch L_chk0_1
L_rty0_2:
    s_cmp_eq_u32 s39, 0
    s_cbranch_scc1 L_ok0_2
    s_sub_u32 s39, s39, 1
    global_load_dwordx4 v[40:43], v165, s[30:31] offset:0 sc1
    global_load_dwordx4 v[44:47], v165, s[30:31] offset:1024 sc1
    s_waitcnt vmcnt(1)
    s_branch L_chk0_2
L_rty0_3:
    s_cmp_eq_u32 s39, 0
    s_cbranch_scc1 L_ok0_3
    s_sub_u32 s39, s39, 1
    global_load_dwordx4 v[44:47], v165, s[30:31] offset:1024 sc1
    s_waitcnt vmcnt(0)
    s_branch L_chk0_3
L_rty1_0:
    s_cmp_eq_u32 s39, 0
    s_cbranch_scc1 L_ok1_0
    s_sub_u32 s39, s39, 1
    global_load_dword v32, v222, s[30:31] offset:0 sc1
    global_load_dword v33, v222, s[30:31] offset:256 sc1
    global_load_dword v34, v222, s[30:31] offset:512 sc1
    global_load_dword v35, v222, s[30:31] offset:768 sc1
    global_load_dword v36, v236, s[30:31] offset:0 sc1
    global_load_dword v37, v236, s[30:31] offset:256 sc1
    global_load_dword v38, v236, s[30:31] offset:512 sc1
    global_load_dword v39, v236, s[30:31] offset:768 sc1
    global_load_dword v40, v237, s[30:31] offset:0 sc1
    global_load_dword v41, v237, s[30:31] offset:256 sc1
    global_load_dword v42, v237, s[30:31] offset:512 sc1
    global_load_dword v43, v237, s[30:31] offset:768 sc1
    s_waitcnt vmcnt(11)
    s_branch L_chk1_0
L_rty1_1:
    s_cmp_eq_u32 s39, 0
    s_cbranch_scc1 L_ok1_1
    s_sub_u32 s39, s39, 1
    global_load_dword v33, v222, s[30:31] offset:256 sc1
    global_load_dword v34, v222, s[30:31] offset:512 sc1
    global_load_dword v35, v222, s[30:31] offset:768 sc1
    global_load_dword v36, v236, s[30:31] offset:0 sc1
    global_load_dword v37, v236, s[30:31] offset:256 sc1
    global_load_dword v38, v236, s[30:31] offset:512 sc1
    global_load_dword v39, v236, s[30:31] offset:768 sc1
    global_load_dword v40, v237, s[30:31] offset:0 sc1
    global_load_dword v41, v237, s[30:31] offset:256 sc1
    global_load_dword v42, v237, s[30:31] offset:512 sc1
    global_load_dword v43, v237, s[30:31] offset:768 sc1
    s_waitcnt vmcnt(10)
    s_branch L_chk1_1
L_rty1_2:
    s_cmp_eq_u32 s39, 0
    s_cbranch_scc1 L_ok1_2
    s_sub_u32 s39, s39, 1
    global_load_dword v34, v222, s[30:31] offset:512 sc1
    global_load_dword v35, v222, s[30:31] offset:768 sc1
    global_load_dword v36, v236, s[30:31] offset:0 sc1
    global_load_dword v37, v236, s[30:31] offset:256 sc1
    global_load_dword v38, v236, s[30:31] offset:512 sc1
    global_load_dword v39, v236, s[30:31] offset:768 sc1
    global_load_dword v40, v237, s[30:31] offset:0 sc1
    global_load_dword v41, v237, s[30:31] offset:256 sc1
    global_load_dword v42, v237, s[30:31] offset:512 sc1
    global_load_dword v43, v237, s[30:31] offset:768 sc1
    s_waitcnt vmcnt(9)
    s_branch L_chk1_2
L_rty1_3:
    s_cmp_eq_u32 s39, 0
    s_cbranch_scc1 L_ok1_3
    s_sub_u32 s39, s39, 1
    global_load_dword v35, v222, s[30:31] offset:768 sc1
    global_load_dword v36, v236, s[30:31] offset:0 sc1
    global_load_dword v37, v236, s[30:31] offset:256 sc1
    global_load_dword v38, v236, s[30:31] offset:512 sc1
    global_load_dword v39, v236, s[30:31] offset:768 sc1
    global_load_dword v40, v237, s[30:31] offset:0 sc1
    global_load_dword v41, v237, s[30:31] offset:256 sc1
    global_load_dword v42, v237, s[30:31] offset:512 sc1
    global_load_dword v43, v237, s[30:31] offset:768 sc1
    s_waitcnt vmcnt(8)
    s_branch L_chk1_3
L_rty1_4:
    s_cmp_eq_u32 s39, 0
    s_cbranch_scc1 L_ok1_4
    s_sub_u32 s39, s39, 1
    global_load_dword v36, v236, s[30:31] offset:0 sc1
    global_load_dword v37, v236, s[30:31] offset:256 sc1
    global_load_dword v38, v236, s[30:31] offset:512 sc1
    global_load_dword v39, v236, s[30:31] offset:768 sc1
    global_load_dword v40, v237, s[30:31] offset:0 sc1
    global_load_dword v41, v237, s[30:31] offset:256 sc1
    global_load_dword v42, v237, s[30:31] offset:512 sc1
    global_load_dword v43, v237, s[30:31] offset:768 sc1
    s_waitcnt vmcnt(7)
    s_branch L_chk1_4
L_rty1_5:
    s_cmp_eq_u32 s39, 0
    s_cbranch_scc1 L_ok1_5
    s_sub_u32 s39, s39, 1
    global_load_dword v37, v236, s[30:31] offset:256 sc1
    global_load_dword v38, v236, s[30:31] offset:512 sc1
    global_load_dword v39, v236, s[30:31] offset:768 sc1
    global_load_dword v40, v237, s[30:31] offset:0 sc1
    global_load_dword v41, v237, s[30:31] offset:256 sc1
    global_load_dword v42, v237, s[30:31] offset:512 sc1
    global_load_dword v43, v237, s[30:31] offset:768 sc1
    s_waitcnt vmcnt(6)
    s_branch L_chk1_5
L_rty1_6:
    s_cmp_eq_u32 s39, 0
    s_cbranch_scc1 L_ok1_6
    s_sub_u32 s39, s39, 1
    global_load_dword v38, v236, s[30:31] offset:512 sc1
    global_load_dword v39, v236, s[30:31] offset:768 sc1
    global_load_dword v40, v237, s[30:31] offset:0 sc1
    global_load_dword v41, v237, s[30:31] offset:256 sc1
    global_load_dword v42, v237, s[30:31] offset:512 sc1
    global_load_dword v43, v237, s[30:31] offset:768 sc1
    s_waitcnt vmcnt(5)
    s_branch L_chk1_6
L_rty1_7:
    s_cmp_eq_u32 s39, 0
    s_cbranch_scc1 L_ok1_7
    s_sub_u32 s39, s39, 1
    global_load_dword v39, v236, s[30:31] offset:768 sc1
    global_load_dword v40, v237, s[30:31] offset:0 sc1
    global_load_dword v41, v237, s[30:31] offset:256 sc1
    global_load_dword v42, v237, s[30:31] offset:512 sc1
    global_load_dword v43, v237, s[30:31] offset:768 sc1
    s_waitcnt vmcnt(4)
    s_branch L_chk1_7
L_rty1_8:
    s_cmp_eq_u32 s39, 0
    s_cbranch_scc1 L_ok1_8
    s_sub_u32 s39, s39, 1
    global_load_dword v40, v237, s[30:31] offset:0 sc1
    global_load_dword v41, v237, s[30:31] offset:256 sc1
    global_load_dword v42, v237, s[30:31] offset:512 sc1
    global_load_dword v43, v237, s[30:31] offset:768 sc1
    s_waitcnt vmcnt(3)
    s_branch L_chk1_8
L_rty1_9:
    s_cmp_eq_u32 s39, 0
    s_cbranch_scc1 L_ok1_9
    s_sub_u32 s39, s39, 1
    global_load_dword v41, v237, s[30:31] offset:256 sc1
    global_load_dword v42, v237, s[30:31] offset:512 sc1
    global_load_dword v43, v237, s[30:31] offset:768 sc1
    s_waitcnt vmcnt(2)
    s_branch L_chk1_9
L_rty1_10:
    s_cmp_eq_u32 s39, 0
    s_cbranch_scc1 L_ok1_10
    s_sub_u32 s39, s39, 1
    global_load_dword v42, v237, s[30:31] offset:512 sc1
    global_load_dword v43, v237, s[30:31] offset:768 sc1
    s_waitcnt vmcnt(1)
    s_branch L_chk1_10
L_rty1_11:
    s_cmp_eq_u32 s39, 0
    s_cbranch_scc1 L_ok1_11
    s_sub_u32 s39, s39, 1
    global_load_dword v43, v237, s[30:31] offset:768 sc1
    s_waitcnt vmcnt(0)
    s_branch L_chk1_11
L_rty2_0:
    s_cmp_eq_u32 s39, 0
    s_cbranch_scc1 L_ok2_0
    s_sub_u32 s39, s39, 1
    global_load_dwordx4 v[32:35], v220, s[30:31] offset:0 sc1
    global_load_dwordx4 v[36:39], v221, s[30:31] offset:0 sc1
    s_waitcnt vmcnt(1)
    s_branch L_chk2_0
L_rty2_1:
    s_cmp_eq_u32 s39, 0
    s_cbranch_scc1 L_ok2_1
    s_sub_u32 s39, s39, 1
    global_load_dwordx4 v[36:39], v221, s[30:31] offset:0 sc1
    s_waitcnt vmcnt(0)
    s_branch L_chk2_1
L_rty3_0:
    s_cmp_eq_u32 s39, 0
    s_cbranch_scc1 L_ok3_0
    s_sub_u32 s39, s39, 1
    s_and_b32 s35, s39, 31
    s_cselect_b32 s35, 983040, 0
    s_cbranch_scc1 L_nst3_0
    global_store_dword v231, v205, s[30:31] sc1
    global_store_dword v231, v209, s[30:31] offset:256 sc1
L_nst3_0:
    s_add_u32 s60, s30, s35
    s_addc_u32 s61, s31, 0
    global_load_dwordx4 v[32:35], v232, s[60:61] offset:0 sc1
    global_load_dwordx4 v[36:39], v232, s[60:61] offset:256 sc1
    s_waitcnt vmcnt(1)
    s_branch L_chk3_0
L_rty3_1:
    s_cmp_eq_u32 s39, 0
    s_cbranch_scc1 L_ok3_1
    s_sub_u32 s39, s39, 1
    s_and_b32 s35, s39, 31
    s_cselect_b32 s35, 983040, 0
    s_cbranch_scc1 L_nst3_1
    global_store_dword v231, v205, s[30:31] sc1
    global_store_dword v231, v209, s[30:31] offset:256 sc1
L_nst3_1:
    s_add_u32 s60, s30, s35
    s_addc_u32 s61, s31, 0
    global_load_dwordx4 v[36:39], v232, s[60:61] offset:256 sc1
    s_waitcnt vmcnt(0)
    s_branch L_chk3_1
L_COMB:
    s_lshl_b32 s43, s32, 2
    s_add_u32 s43, s43, s44
    s_sub_u32 s43, s43, 28
    s_mul_i32 s36, s43, 2176
    s_lshl_b32 s38, s34, 9
    s_add_u32 s36, s36, s38
    s_add_u32 s36, s36, 980992
    v_add_u32 v25, s36, v4
    v_mov_b32 v32, v5
    v_mov_b32 v33, v5
    v_mov_b32 v34, v5
    v_mov_b32 v35, v5
    s_mov_b32 exec_hi, 0
    global_store_dwordx4 v25, v[32:35], s[30:31] sc1
    s_mov_b64 exec, -1
L_comb_done:
    s_endpgm
L_A0:
    s_cmp_eq_u32 s34, 4
    s_cbranch_scc1 L_helper
    v_lshrrev_b32 v8, 4, v1
    v_bfe_u32 v22, v1, 2, 2
    v_and_b32 v23, 3, v1
    s_lshl_b32 s35, s33, 12
    s_lshl_b32 s38, s34, 10
    s_add_u32 s35, s35, s38
    v_lshlrev_b32 v244, 8, v22
    v_lshl_add_u32 v244, v8, 6, v244
    v_lshl_add_u32 v244, v23, 4, v244
    v_add_u32 v244, s35, v244
    s_add_u32 s35, s35, 524288
    s_and_b32 s35, s35, 0xfffff
    v_add_u32 v245, s35, v4
    s_lshl_b32 s35, s32, 24
    s_add_u32 s35, s35, 15728640
    s_waitcnt lgkmcnt(0)
    s_add_u32 s6, s6, s35
    s_addc_u32 s7, s7, 0
    global_load_dword v6, v10, s[30:31] sc1
    global_load_dwordx4 v[84:87], v244, s[6:7] nt
    v_add_u32 v244, 0x10000, v244
    global_load_dwordx4 v[88:91], v244, s[6:7] nt
    v_add_u32 v244, 0x10000, v244
    global_load_dwordx4 v[92:95], v244, s[6:7] nt
    v_add_u32 v244, 0x10000, v244
    global_load_dwordx4 v[96:99], v244, s[6:7] nt
    v_add_u32 v244, 0x10000, v244
    s_waitcnt vmcnt(4)
    global_load_dwordx4 v[100:103], v244, s[6:7] nt
    v_add_u32 v244, 0x10000, v244
    global_load_dwordx4 v[104:107], v244, s[6:7] nt
    v_add_u32 v244, 0x10000, v244
    global_load_dwordx4 v[108:111], v244, s[6:7] nt
    v_add_u32 v244, 0x10000, v244
    global_load_dwordx4 v[112:115], v244, s[6:7] nt
    v_add_u32 v244, 0x10000, v244
    s_waitcnt vmcnt(7)
    global_load_dwordx4 v[116:119], v244, s[6:7] nt
    v_add_u32 v244, 0x10000, v244
    s_waitcnt vmcnt(7)
    global_load_dwordx4 v[120:123], v244, s[6:7] nt
    v_add_u32 v244, 0x10000, v244
    s_waitcnt vmcnt(7)
    global_load_dwordx4 v[124:127], v244, s[6:7] nt
    v_add_u32 v244, 0x10000, v244
    s_waitcnt vmcnt(7)
    global_load_dwordx4 v[128:131], v244, s[6:7] nt
    v_add_u32 v244, 0x10000, v244
    s_waitcnt vmcnt(7)
    global_load_dwordx4 v[132:135], v244, s[6:7] nt
    v_add_u32 v244, 0x10000, v244
    s_waitcnt vmcnt(7)
    global_load_dwordx4 v[136:139], v244, s[6:7] nt
    v_add_u32 v244, 0x10000, v244
    s_waitcnt vmcnt(7)
    global_load_dwordx4 v[140:143], v244, s[6:7] nt
    v_add_u32 v244, 0x10000, v244
    s_waitcnt vmcnt(7)
    global_load_dwordx4 v[144:147], v244, s[6:7] nt
    s_add_u32 s8, s8, s35
    s_addc_u32 s9, s9, 0
    s_waitcnt vmcnt(7)
    global_load_dwordx4 v[180:183], v245, s[8:9] nt
    v_add_u32 v245, 0x10000, v245
    s_waitcnt vmcnt(7)
    global_load_dwordx4 v[184:187], v245, s[8:9] nt
    v_add_u32 v245, 0x10000, v245
    s_waitcnt vmcnt(7)
    global_load_dwordx4 v[188:191], v245, s[8:9] nt
    v_add_u32 v245, 0x10000, v245
    s_waitcnt vmcnt(7)
    global_load_dwordx4 v[192:195], v245, s[8:9] nt
    v_add_u32 v245, 0x10000, v245
    s_waitcnt vmcnt(7)
    global_load_dwordx4 v[196:199], v245, s[8:9] nt
    v_add_u32 v245, 0x10000, v245
    s_waitcnt vmcnt(7)
    global_load_dwordx4 v[200:203], v245, s[8:9] nt
    v_add_u32 v245, 0x10000, v245
    s_waitcnt vmcnt(7)
    global_load_dwordx4 v[204:207], v245, s[8:9] nt
    v_add_u32 v245, 0x10000, v245
    s_waitcnt vmcnt(7)
    global_load_dwordx4 v[208:211], v245, s[8:9] nt
    v_add_u32 v245, 0x10000, v245
    v_and_b32 v245, 0xfffff, v245
    s_waitcnt vmcnt(7)
    global_load_dwordx4 v[148:151], v245, s[8:9] nt
    v_add_u32 v245, 0x10000, v245
    s_waitcnt vmcnt(7)
    global_load_dwordx4 v[152:155], v245, s[8:9] nt
    v_add_u32 v245, 0x10000, v245
    s_waitcnt vmcnt(7)
    global_load_dwordx4 v[156:159], v245, s[8:9] nt
    v_add_u32 v245, 0x10000, v245
    s_waitcnt vmcnt(7)
    global_load_dwordx4 v[160:163], v245, s[8:9] nt
    v_add_u32 v245, 0x10000, v245
    s_waitcnt vmcnt(7)
    global_load_dwordx4 v[164:167], v245, s[8:9] nt
    v_add_u32 v245, 0x10000, v245
    s_waitcnt vmcnt(7)
    global_load_dwordx4 v[168:171], v245, s[8:9] nt
    v_add_u32 v245, 0x10000, v245
    s_waitcnt vmcnt(7)
    global_load_dwordx4 v[172:175], v245, s[8:9] nt
    v_add_u32 v245, 0x10000, v245
    s_waitcnt vmcnt(7)
    global_load_dwordx4 v[176:179], v245, s[8:9] nt
    v_and_b32 v9, 15, v1
    v_bfe_u32 v25, v1, 4, 1
    v_lshrrev_b32 v24, 5, v1
    v_lshl_add_u32 v7, v25, 1, v24
    s_mov_b32 s40, 0x3fb8aa3b
    s_mov_b32 s41, 0xffff0000
    s_movk_i32 s42, 0xff
    s_mov_b32 s46, 0x00ff00ff
    s_mov_b32 s47, 0xff00ff00
    s_mov_b32 s62, 0x11111111
    s_mov_b32 s63, 0x11111111
    v_lshlrev_b32 v12, 2, v1
    v_and_b32 v27, 1, v1
    v_lshlrev_b32 v27, 4, v27
    v_mov_b32 v29, 0xffff
    v_lshlrev_b32 v27, v27, v29
    v_lshrrev_b32 v29, 1, v3
    v_cmp_eq_u32 s[48:49], 0, v29
    v_cmp_eq_u32 s[50:51], 1, v29
    v_cmp_eq_u32 s[52:53], 2, v29
    v_cmp_eq_u32 s[54:55], 3, v29
    v_cndmask_b32 v14, 0, v27, s[48:49]
    v_cndmask_b32 v15, 0, v27, s[50:51]
    v_cndmask_b32 v16, 0, v27, s[52:53]
    v_cndmask_b32 v17, 0, v27, s[54:55]
    v_lshrrev_b32 v28, 5, v1
    v_bfe_u32 v29, v1, 4, 1
    s_lshl_b32 s38, s34, 9
    v_lshlrev_b32 v18, 8, v28
    v_lshl_add_u32 v18, v29, 4, v18
    v_lshl_add_u32 v18, v3, 5, v18
    v_add_u32 v18, s38, v18
    s_lshl_b32 s35, s34, 8
    s_add_u32 s35, s35, 4096
    v_lshlrev_b32 v19, 4, v9
    v_lshl_add_u32 v19, v7, 2, v19
    v_add_u32 v19, s35, v19
    v_lshl_add_u32 v20, v2, 5, s35
    s_add_u32 s60, s30, 983040
    s_addc_u32 s61, s31, 0
    v_and_b32 v29, 2, v1
    v_cmp_eq_u32 vcc, 0, v29
    s_nop 1
    v_cndmask_b32 v246, 0, v27, vcc
    v_cndmask_b32 v247, v27, 0, vcc
    s_mov_b32 s48, 0x22222222
    s_mov_b32 s49, 0x22222222
    s_mov_b32 s50, 0x44444444
    s_mov_b32 s51, 0x44444444
    s_mov_b32 s52, 0x88888888
    s_mov_b32 s53, 0x88888888
    s_mov_b32 s58, 0x3db504f3
    s_mov_b32 s59, 0x3db504f3
    s_and_b32 s35, s33, 1
    s_lshr_b32 s36, s34, 1
    s_lshl_b32 s56, s35, 1
    s_add_u32 s56, s56, s36
    s_and_b32 s57, s34, 1
    s_lshr_b32 s36, s33, 1
    s_lshl_b32 s35, s32, 19
    s_lshl_b32 s38, s56, 17
    s_add_u32 s35, s35, s38
    s_lshl_b32 s38, s57, 12
    s_add_u32 s35, s35, s38
    s_lshl_b32 s38, s36, 7
    s_add_u32 s35, s35, s38
    v_lshlrev_b32 v248, 14, v2
    v_lshl_add_u32 v248, v3, 4, v248
    v_add_u32 v248, s35, v248
    v_add_u32 v249, 8192, v248
    s_mul_i32 s35, s32, 34816
    s_lshl_b32 s38, s56, 9
    s_add_u32 s35, s35, s38
    s_lshl_b32 s38, s57, 8
    s_add_u32 s35, s35, s38
    s_add_u32 s35, s35, 133248
    v_mul_u32_u24 v244, 8704, v8
    v_lshl_add_u32 v244, v9, 4, v244
    v_add_u32 v244, s35, v244
    s_lshl_b32 s35, s32, 10
    s_lshl_b32 s38, s56, 8
    s_add_u32 s35, s35, s38
    s_add_u32 s35, s35, 409600
    v_and_b32 v23, 3, v1
    v_lshlrev_b32 v245, 6, v8
    v_lshl_add_u32 v245, v23, 4, v245
    v_add_u32 v245, s35, v245
    s_lshl_b32 s36, s34, 11
    s_add_u32 s36, s36, 8448
    v_add_u32 v26, s36, v4
    s_lshl_b32 s35, s34, 3
    v_lshl_add_u32 v27, v1, 3, s35
    s_lshl_b32 s36, s34, 5
    v_lshl_add_u32 v28, v23, 3, s36
    v_and_b32 v22, 31, v1
    s_lshl_b32 s36, s34, 8
    s_add_u32 s36, s36, 8448
    v_lshlrev_b32 v29, 3, v22
    v_lshl_add_u32 v29, v24, 10, v29
    v_add_u32 v29, s36, v29
    s_lshl_b32 s36, s32, 4
    s_add_u32 s36, s36, s33
    s_mul_i32 s36, s36, 2176
    s_lshl_b32 s38, s34, 9
    s_add_u32 s36, s36, s38
    s_add_u32 s36, s36, 131072
    v_lshl_add_u32 v31, v1, 3, s36
    s_lshl_b32 s36, s32, 10
    s_lshl_b32 s38, s34, 8
    s_add_u32 s36, s36, s38
    s_lshl_b32 s38, s33, 4
    s_add_u32 s36, s36, s38
    s_add_u32 s36, s36, 409600
    s_waitcnt vmcnt(32)
    v_mov_b32 v11, s36
    v_add_u32 v6, 1, v6
    v_and_b32 v5, 0xff, v6
    s_barrier
    ds_read_b128 v[56:59], v4 offset:5120
    s_waitcnt vmcnt(16) lgkmcnt(0)
    v_mfma_f32_16x16x32_bf16 v[64:67], v[84:87], v[56:59], 0
    v_mfma_f32_16x16x32_bf16 v[68:71], v[88:91], v[56:59], 0
    v_mfma_f32_16x16x32_bf16 v[72:75], v[92:95], v[56:59], 0
    v_mfma_f32_16x16x32_bf16 v[76:79], v[96:99], v[56:59], 0
    s_nop 4
    v_mov_b32_dpp v32, v64 quad_perm:[0,0,0,0] row_mask:0xf bank_mask:0xf
    v_add_f32_dpp v32, v65, v32 quad_perm:[1,1,1,1] row_mask:0xf bank_mask:0xf
    v_add_f32_dpp v32, v66, v32 quad_perm:[2,2,2,2] row_mask:0xf bank_mask:0xf
    v_add_f32_dpp v32, v67, v32 quad_perm:[3,3,3,3] row_mask:0xf bank_mask:0xf
    v_mfma_f32_16x16x32_bf16 v[64:67], v[100:103], v[56:59], 0
    v_mov_b32_dpp v33, v68 quad_perm:[0,0,0,0] row_mask:0xf bank_mask:0xf
    v_add_f32_dpp v33, v69, v33 quad_perm:[1,1,1,1] row_mask:0xf bank_mask:0xf
    v_add_f32_dpp v33, v70, v33 quad_perm:[2,2,2,2] row_mask:0xf bank_mask:0xf
    v_add_f32_dpp v33, v71, v33 quad_perm:[3,3,3,3] row_mask:0xf bank_mask:0xf
    v_mfma_f32_16x16x32_bf16 v[68:71], v[104:107], v[56:59], 0
    v_mov_b32_dpp v34, v72 quad_perm:[0,0,0,0] row_mask:0xf bank_mask:0xf
    v_add_f32_dpp v34, v73, v34 quad_perm:[1,1,1,1] row_mask:0xf bank_mask:0xf
    v_add_f32_dpp v34, v74, v34 quad_perm:[2,2,2,2] row_mask:0xf bank_mask:0xf
    v_add_f32_dpp v34, v75, v34 quad_perm:[3,3,3,3] row_mask:0xf bank_mask:0xf
    v_mfma_f32_16x16x32_bf16 v[72:75], v[108:111], v[56:59], 0
    v_mov_b32_dpp v35, v76 quad_perm:[0,0,0,0] row_mask:0xf bank_mask:0xf
    v_add_f32_dpp v35, v77, v35 quad_perm:[1,1,1,1] row_mask:0xf bank_mask:0xf
    v_add_f32_dpp v35, v78, v35 quad_perm:[2,2,2,2] row_mask:0xf bank_mask:0xf
    v_add_f32_dpp v35, v79, v35 quad_perm:[3,3,3,3] row_mask:0xf bank_mask:0xf
    v_cndmask_b32 v80, v32, v33, s[48:49]
    v_cndmask_b32 v80, v80, v34, s[50:51]
    v_cndmask_b32 v80, v80, v35, s[52:53]
    v_mfma_f32_16x16x32_bf16 v[76:79], v[112:115], v[56:59], 0
    v_mov_b32_dpp v36, v64 quad_perm:[0,0,0,0] row_mask:0xf bank_mask:0xf
    v_add_f32_dpp v36, v65, v36 quad_perm:[1,1,1,1] row_mask:0xf bank_mask:0xf
    v_add_f32_dpp v36, v66, v36 quad_perm:[2,2,2,2] row_mask:0xf bank_mask:0xf
    v_add_f32_dpp v36, v67, v36 quad_perm:[3,3,3,3] row_mask:0xf bank_mask:0xf
    v_mfma_f32_16x16x32_bf16 v[64:67], v[116:119], v[56:59], 0
    v_mov_b32_dpp v37, v68 quad_perm:[0,0,0,0] row_mask:0xf bank_mask:0xf
    v_add_f32_dpp v37, v69, v37 quad_perm:[1,1,1,1] row_mask:0xf bank_mask:0xf
    v_add_f32_dpp v37, v70, v37 quad_perm:[2,2,2,2] row_mask:0xf bank_mask:0xf
    v_add_f32_dpp v37, v71, v37 quad_perm:[3,3,3,3] row_mask:0xf bank_mask:0xf
    v_mfma_f32_16x16x32_bf16 v[68:71], v[120:123], v[56:59], 0
    v_mov_b32_dpp v38, v72 quad_perm:[0,0,0,0] row_mask:0xf bank_mask:0xf
    v_add_f32_dpp v38, v73, v38 quad_perm:[1,1,1,1] row_mask:0xf bank_mask:0xf
    v_add_f32_dpp v38, v74, v38 quad_perm:[2,2,2,2] row_mask:0xf bank_mask:0xf
    v_add_f32_dpp v38, v75, v38 quad_perm:[3,3,3,3] row_mask:0xf bank_mask:0xf
    v_mfma_f32_16x16x32_bf16 v[72:75], v[124:127], v[56:59], 0
    v_mov_b32_dpp v39, v76 quad_perm:[0,0,0,0] row_mask:0xf bank_mask:0xf
    v_add_f32_dpp v39, v77, v39 quad_perm:[1,1,1,1] row_mask:0xf bank_mask:0xf
    v_add_f32_dpp v39, v78, v39 quad_perm:[2,2,2,2] row_mask:0xf bank_mask:0xf
    v_add_f32_dpp v39, v79, v39 quad_perm:[3,3,3,3] row_mask:0xf bank_mask:0xf
    v_cndmask_b32 v81, v36, v37, s[48:49]
    v_cndmask_b32 v81, v81, v38, s[50:51]
    v_cndmask_b32 v81, v81, v39, s[52:53]
    v_mfma_f32_16x16x32_bf16 v[76:79], v[128:131], v[56:59], 0
    v_mov_b32_dpp v40, v64 quad_perm:[0,0,0,0] row_mask:0xf bank_mask:0xf
    v_add_f32_dpp v40, v65, v40 quad_perm:[1,1,1,1] row_mask:0xf bank_mask:0xf
    v_add_f32_dpp v40, v66, v40 quad_perm:[2,2,2,2] row_mask:0xf bank_mask:0xf
    v_add_f32_dpp v40, v67, v40 quad_perm:[3,3,3,3] row_mask:0xf bank_mask:0xf
    v_mfma_f32_16x16x32_bf16 v[64:67], v[132:135], v[56:59], 0
    v_mov_b32_dpp v41, v68 quad_perm:[0,0,0,0] row_mask:0xf bank_mask:0xf
    v_add_f32_dpp v41, v69, v41 quad_perm:[1,1,1,1] row_mask:0xf bank_mask:0xf
    v_add_f32_dpp v41, v70, v41 quad_perm:[2,2,2,2] row_mask:0xf bank_mask:0xf
    v_add_f32_dpp v41, v71, v41 quad_perm:[3,3,3,3] row_mask:0xf bank_mask:0xf
    v_mfma_f32_16x16x32_bf16 v[68:71], v[136:139], v[56:59], 0
    v_mov_b32_dpp v42, v72 quad_perm:[0,0,0,0] row_mask:0xf bank_mask:0xf
    v_add_f32_dpp v42, v73, v42 quad_perm:[1,1,1,1] row_mask:0xf bank_mask:0xf
    v_add_f32_dpp v42, v74, v42 quad_perm:[2,2,2,2] row_mask:0xf bank_mask:0xf
    v_add_f32_dpp v42, v75, v42 quad_perm:[3,3,3,3] row_mask:0xf bank_mask:0xf
    v_mfma_f32_16x16x32_bf16 v[72:75], v[140:143], v[56:59], 0
    v_mov_b32_dpp v43, v76 quad_perm:[0,0,0,0] row_mask:0xf bank_mask:0xf
    v_add_f32_dpp v43, v77, v43 quad_perm:[1,1,1,1] row_mask:0xf bank_mask:0xf
    v_add_f32_dpp v43, v78, v43 quad_perm:[2,2,2,2] row_mask:0xf bank_mask:0xf
    v_add_f32_dpp v43, v79, v43 quad_perm:[3,3,3,3] row_mask:0xf bank_mask:0xf
    v_cndmask_b32 v82, v40, v41, s[48:49]
    v_cndmask_b32 v82, v82, v42, s[50:51]
    v_cndmask_b32 v82, v82, v43, s[52:53]
    v_mfma_f32_16x16x32_bf16 v[76:79], v[144:147], v[56:59], 0
    v_mov_b32_dpp v44, v64 quad_perm:[0,0,0,0] row_mask:0xf bank_mask:0xf
    v_add_f32_dpp v44, v65, v44 quad_perm:[1,1,1,1] row_mask:0xf bank_mask:0xf
    v_add_f32_dpp v44, v66, v44 quad_perm:[2,2,2,2] row_mask:0xf bank_mask:0xf
    v_add_f32_dpp v44, v67, v44 quad_perm:[3,3,3,3] row_mask:0xf bank_mask:0xf
    v_mov_b32_dpp v45, v68 quad_perm:[0,0,0,0] row_mask:0xf bank_mask:0xf
    v_add_f32_dpp v45, v69, v45 quad_perm:[1,1,1,1] row_mask:0xf bank_mask:0xf
    v_add_f32_dpp v45, v70, v45 quad_perm:[2,2,2,2] row_mask:0xf bank_mask:0xf
    v_add_f32_dpp v45, v71, v45 quad_perm:[3,3,3,3] row_mask:0xf bank_mask:0xf
    v_mov_b32_dpp v46, v72 quad_perm:[0,0,0,0] row_mask:0xf bank_mask:0xf
    v_add_f32_dpp v46, v73, v46 quad_perm:[1,1,1,1] row_mask:0xf bank_mask:0xf
    v_add_f32_dpp v46, v74, v46 quad_perm:[2,2,2,2] row_mask:0xf bank_mask:0xf
    v_add_f32_dpp v46, v75, v46 quad_perm:[3,3,3,3] row_mask:0xf bank_mask:0xf
    v_mov_b32_dpp v47, v76 quad_perm:[0,0,0,0] row_mask:0xf bank_mask:0xf
    v_add_f32_dpp v47, v77, v47 quad_perm:[1,1,1,1] row_mask:0xf bank_mask:0xf
    v_add_f32_dpp v47, v78, v47 quad_perm:[2,2,2,2] row_mask:0xf bank_mask:0xf
    v_add_f32_dpp v47, v79, v47 quad_perm:[3,3,3,3] row_mask:0xf bank_mask:0xf
    v_cndmask_b32 v83, v44, v45, s[48:49]
    v_cndmask_b32 v83, v83, v46, s[50:51]
    v_cndmask_b32 v83, v83, v47, s[52:53]
    v_cvt_pk_bf16_f32 v22, v80, v81
    v_cvt_pk_bf16_f32 v23, v82, v83
    v_lshlrev_b32 v32, 16, v22
    v_and_b32 v33, s41, v22
    v_lshlrev_b32 v34, 16, v23
    v_and_b32 v35, s41, v23
    v_pk_mul_f32 v[32:33], v[32:33], s[58:59]
    v_pk_mul_f32 v[34:35], v[34:35], s[58:59]
    v_cvt_pk_bf16_f32 v22, v32, v33
    v_cvt_pk_bf16_f32 v23, v34, v35
    v_lshlrev_b32 v32, 16, v22
    v_and_b32 v33, s41, v22
    v_lshlrev_b32 v34, 16, v23
    v_and_b32 v35, s41, v23
    v_max3_f32 v60, v32, v33, v34
    v_max_f32 v60, v60, v35
    s_nop 1
    v_max_f32_dpp v60, v60, v60 quad_perm:[1,0,3,2] row_mask:0xf bank_mask:0xf
    s_nop 1
    v_max_f32_dpp v60, v60, v60 quad_perm:[2,3,0,1] row_mask:0xf bank_mask:0xf
    v_mov_b32 v23, v60
    s_nop 1
    v_permlane16_swap_b32 v60, v23
    v_max_f32 v60, v60, v23
    v_mov_b32 v23, v60
    s_nop 1
    v_permlane32_swap_b32 v60, v23
    v_max_f32 v60, v60, v23
    v_sub_f32 v32, v32, v60
    v_sub_f32 v33, v33, v60
    v_sub_f32 v34, v34, v60
    v_sub_f32 v35, v35, v60
    v_mul_f32 v32, s40, v32
    v_mul_f32 v33, s40, v33
    v_mul_f32 v34, s40, v34
    v_mul_f32 v35, s40, v35
    v_exp_f32 v32, v32
    v_exp_f32 v33, v33
    v_exp_f32 v34, v34
    v_exp_f32 v35, v35
    v_cvt_pk_bf16_f32 v40, v32, v32
    v_cvt_pk_bf16_f32 v41, v33, v33
    v_cvt_pk_bf16_f32 v42, v34, v34
    v_cvt_pk_bf16_f32 v43, v35, v35
    v_pk_add_f32 v[32:33], v[32:33], v[34:35]
    v_add_f32 v61, v32, v33
    v_and_b32_dpp v64, v42, v246 quad_perm:[0,0,0,0] row_mask:0xf bank_mask:0xf
    v_and_b32_dpp v65, v42, v247 quad_perm:[0,0,0,0] row_mask:0xf bank_mask:0xf
    v_and_b32_dpp v66, v42, v246 quad_perm:[1,1,1,1] row_mask:0xf bank_mask:0xf
    v_and_b32_dpp v67, v42, v247 quad_perm:[1,1,1,1] row_mask:0xf bank_mask:0xf
    s_waitcnt vmcnt(14)
    v_swap_b32 v182, v184
    v_swap_b32 v183, v185
    v_add_f32_dpp v61, v61, v61 quad_perm:[1,0,3,2] row_mask:0xf bank_mask:0xf
    s_nop 0
    v_mfma_f32_16x16x32_bf16 v[48:51], v[64:67], v[180:183], 0
    v_mfma_f32_16x16x32_bf16 v[52:55], v[64:67], v[184:187], 0
    global_load_dwordx4 v[212:215], v248, s[12:13] offset:0 nt
    v_and_b32_dpp v68, v42, v246 quad_perm:[2,2,2,2] row_mask:0xf bank_mask:0xf
    v_and_b32_dpp v69, v42, v247 quad_perm:[2,2,2,2] row_mask:0xf bank_mask:0xf
    v_and_b32_dpp v70, v42, v246 quad_perm:[3,3,3,3] row_mask:0xf bank_mask:0xf
    v_and_b32_dpp v71, v42, v247 quad_perm:[3,3,3,3] row_mask:0xf bank_mask:0xf
    s_waitcnt vmcnt(13)
    v_swap_b32 v190, v192
    v_swap_b32 v191, v193
    v_add_f32_dpp v61, v61, v61 quad_perm:[2,3,0,1] row_mask:0xf bank_mask:0xf
    s_nop 0
    v_mfma_f32_16x16x32_bf16 v[48:51], v[68:71], v[188:191], v[48:51]
    v_mfma_f32_16x16x32_bf16 v[52:55], v[68:71], v[192:195], v[52:55]
    global_load_dwordx4 v[216:219], v248, s[12:13] offset:1024 nt
    v_and_b32_dpp v72, v43, v246 quad_perm:[0,0,0,0] row_mask:0xf bank_mask:0xf
    v_and_b32_dpp v73, v43, v247 quad_perm:[0,0,0,0] row_mask:0xf bank_mask:0xf
    v_and_b32_dpp v74, v43, v246 quad_perm:[1,1,1,1] row_mask:0xf bank_mask:0xf
    v_and_b32_dpp v75, v43, v247 quad_perm:[1,1,1,1] row_mask:0xf bank_mask:0xf
    s_waitcnt vmcnt(12)
    v_swap_b32 v198, v200
    v_swap_b32 v199, v201
    v_mov_b32 v23, v61
    s_nop 0
    v_mfma_f32_16x16x32_bf16 v[48:51], v[72:75], v[196:199], v[48:51]
    v_mfma_f32_16x16x32_bf16 v[52:55], v[72:75], v[200:203], v[52:55]
    global_load_dwordx4 v[220:223], v248, s[12:13] offset:2048 nt
    v_and_b32_dpp v76, v43, v246 quad_perm:[2,2,2,2] row_mask:0xf bank_mask:0xf
    v_and_b32_dpp v77, v43, v247 quad_perm:[2,2,2,2] row_mask:0xf bank_mask:0xf
    v_and_b32_dpp v78, v43, v246 quad_perm:[3,3,3,3] row_mask:0xf bank_mask:0xf
    v_and_b32_dpp v79, v43, v247 quad_perm:[3,3,3,3] row_mask:0xf bank_mask:0xf
    s_waitcnt vmcnt(11)
    v_swap_b32 v206, v208
    v_swap_b32 v207, v209
    v_permlane16_swap_b32 v61, v23
    v_add_f32 v61, v61, v23
    v_mfma_f32_16x16x32_bf16 v[48:51], v[76:79], v[204:207], v[48:51]
    v_mfma_f32_16x16x32_bf16 v[52:55], v[76:79], v[208:211], v[52:55]
    global_load_dwordx4 v[224:227], v248, s[12:13] offset:3072 nt
    v_and_b32_dpp v64, v40, v246 quad_perm:[0,0,0,0] row_mask:0xf bank_mask:0xf
    v_and_b32_dpp v65, v40, v247 quad_perm:[0,0,0,0] row_mask:0xf bank_mask:0xf
    v_and_b32_dpp v66, v40, v246 quad_perm:[1,1,1,1] row_mask:0xf bank_mask:0xf
    v_and_b32_dpp v67, v40, v247 quad_perm:[1,1,1,1] row_mask:0xf bank_mask:0xf
    s_waitcnt vmcnt(10)
    v_swap_b32 v150, v152
    v_swap_b32 v151, v153
    v_mov_b32 v23, v61
    s_nop 0
    v_mfma_f32_16x16x32_bf16 v[48:51], v[64:67], v[148:151], v[48:51]
    v_mfma_f32_16x16x32_bf16 v[52:55], v[64:67], v[152:155], v[52:55]
    global_load_dwordx4 v[228:231], v249, s[12:13] offset:0 nt
    v_and_b32_dpp v68, v40, v246 quad_perm:[2,2,2,2] row_mask:0xf bank_mask:0xf
    v_and_b32_dpp v69, v40, v247 quad_perm:[2,2,2,2] row_mask:0xf bank_mask:0xf
    v_and_b32_dpp v70, v40, v246 quad_perm:[3,3,3,3] row_mask:0xf bank_mask:0xf
    v_and_b32_dpp v71, v40, v247 quad_perm:[3,3,3,3] row_mask:0xf bank_mask:0xf
    s_waitcnt vmcnt(9)
    v_swap_b32 v158, v160
    v_swap_b32 v159, v161
    v_permlane32_swap_b32 v61, v23
    v_add_f32 v61, v61, v23
    v_mfma_f32_16x16x32_bf16 v[48:51], v[68:71], v[156:159], v[48:51]
    v_mfma_f32_16x16x32_bf16 v[52:55], v[68:71], v[160:163], v[52:55]
    global_load_dwordx4 v[232:235], v249, s[12:13] offset:1024 nt
    v_and_b32_dpp v72, v41, v246 quad_perm:[0,0,0,0] row_mask:0xf bank_mask:0xf
    v_and_b32_dpp v73, v41, v247 quad_perm:[0,0,0,0] row_mask:0xf bank_mask:0xf
    v_and_b32_dpp v74, v41, v246 quad_perm:[1,1,1,1] row_mask:0xf bank_mask:0xf
    v_and_b32_dpp v75, v41, v247 quad_perm:[1,1,1,1] row_mask:0xf bank_mask:0xf
    s_waitcnt vmcnt(8)
    v_swap_b32 v166, v168
    v_swap_b32 v167, v169
    s_nop 1
    v_mfma_f32_16x16x32_bf16 v[48:51], v[72:75], v[164:167], v[48:51]
    v_mfma_f32_16x16x32_bf16 v[52:55], v[72:75], v[168:171], v[52:55]
    global_load_dwordx4 v[236:239], v249, s[12:13] offset:2048 nt
    v_and_b32_dpp v76, v41, v246 quad_perm:[2,2,2,2] row_mask:0xf bank_mask:0xf
    v_and_b32_dpp v77, v41, v247 quad_perm:[2,2,2,2] row_mask:0xf bank_mask:0xf
    v_and_b32_dpp v78, v41, v246 quad_perm:[3,3,3,3] row_mask:0xf bank_mask:0xf
    v_and_b32_dpp v79, v41, v247 quad_perm:[3,3,3,3] row_mask:0xf bank_mask:0xf
    s_waitcnt vmcnt(7)
    v_swap_b32 v174, v176
    v_swap_b32 v175, v177
    s_nop 1
    v_mfma_f32_16x16x32_bf16 v[48:51], v[76:79], v[172:175], v[48:51]
    v_mfma_f32_16x16x32_bf16 v[52:55], v[76:79], v[176:179], v[52:55]
    global_load_dwordx4 v[240:243], v249, s[12:13] offset:3072 nt
    s_mov_b64 exec, 0x1111
    ds_write_b64 v27, v[60:61] offset:6144
    s_mov_b64 exec, -1
    v_add_u32 v97, 4352, v244
    s_and_b32 s36, s33, 1
    s_lshl_b32 s35, s32, 1
    s_add_u32 s35, s35, s36
    ds_write_b128 v26, v[48:51]
    ds_write_b128 v26, v[52:55] offset:1024
    s_lshr_b32 s36, s33, 1
    s_mul_i32 s35, s35, 2176
    s_lshl_b32 s38, s36, 8
    s_add_u32 s35, s35, s38
    s_add_u32 s35, s35, 688128
    v_add_u32 v96, s35, v12
    s_waitcnt lgkmcnt(0)
    s_barrier
    ds_read_b64 v[60:61], v28 offset:6144
    ds_read_b64 v[32:33], v29 offset:0
    ds_read_b64 v[34:35], v29 offset:2048
    ds_read_b64 v[36:37], v29 offset:4096
    ds_read_b64 v[38:39], v29 offset:6144
    s_waitcnt lgkmcnt(4)
    v_max_f32_dpp v88, v60, v60 quad_perm:[1,0,3,2] row_mask:0xf bank_mask:0xf
    s_nop 1
    v_max_f32_dpp v88, v88, v88 quad_perm:[2,3,0,1] row_mask:0xf bank_mask:0xf
    v_sub_f32 v60, v60, v88
    v_mul_f32 v60, s40, v60
    v_exp_f32 v60, v60
    v_bfi_b32 v88, s42, v5, v88
    v_mul_f32 v89, v60, v61
    s_waitcnt lgkmcnt(0)
    v_mul_f32_dpp v84, v60, v32 quad_perm:[0,0,0,0] row_mask:0xf bank_mask:0xf
    v_mul_f32_dpp v85, v60, v33 quad_perm:[0,0,0,0] row_mask:0xf bank_mask:0xf
    v_add_f32_dpp v89, v89, v89 quad_perm:[1,0,3,2] row_mask:0xf bank_mask:0xf
    v_fmac_f32_dpp v84, v60, v34 quad_perm:[1,1,1,1] row_mask:0xf bank_mask:0xf
    v_fmac_f32_dpp v85, v60, v35 quad_perm:[1,1,1,1] row_mask:0xf bank_mask:0xf
    v_fmac_f32_dpp v84, v60, v36 quad_perm:[2,2,2,2] row_mask:0xf bank_mask:0xf
    v_fmac_f32_dpp v85, v60, v37 quad_perm:[2,2,2,2] row_mask:0xf bank_mask:0xf
    v_add_f32_dpp v89, v89, v89 quad_perm:[2,3,0,1] row_mask:0xf bank_mask:0xf
    v_fmac_f32_dpp v84, v60, v38 quad_perm:[3,3,3,3] row_mask:0xf bank_mask:0xf
    v_fmac_f32_dpp v85, v60, v39 quad_perm:[3,3,3,3] row_mask:0xf bank_mask:0xf
    v_bfi_b32 v84, s42, v5, v84
    v_bfi_b32 v85, s42, v5, v85
    global_store_dwordx2 v31, v[84:85], s[60:61]
    v_bfi_b32 v89, s42, v5, v89
    v_mov_b32 v90, v88
    v_mov_b32 v91, v89
    s_mov_b64 exec, 1
    global_store_dwordx4 v11, v[88:91], s[60:61]
    s_mov_b64 exec, -1
    s_mov_b32 s39, 20000
    global_load_dwordx4 v[92:95], v245, s[60:61] offset:0 sc1
    global_load_dwordx4 v[32:35], v244, s[60:61] offset:-2176 sc1
    global_load_dwordx4 v[36:39], v244, s[60:61] offset:0 sc1
    global_load_dwordx4 v[40:43], v97, s[60:61] offset:-2176 sc1
    global_load_dwordx4 v[44:47], v97, s[60:61] offset:0 sc1
    s_waitcnt vmcnt(4)
L_chk4_0:
    v_xor_b32 v92, v5, v92
    v_xor_b32 v93, v5, v93
    v_xor_b32 v94, v5, v94
    v_xor_b32 v95, v5, v95
    v_or3_b32 v30, v92, v93, v94
    v_or_b32 v30, v30, v95
    v_cmp_ne_u32_sdwa vcc, v30, v10 src0_sel:BYTE_0 src1_sel:DWORD
    s_cbranch_vccnz L_rty4_0
L_ok4_0:
    v_max_f32_dpp v60, v92, v92 quad_perm:[1,0,3,2] row_mask:0xf bank_mask:0xf
    s_nop 1
    v_max_f32_dpp v60, v60, v60 quad_perm:[2,3,0,1] row_mask:0xf bank_mask:0xf
    v_mov_b32 v23, v60
    s_nop 1
    v_permlane16_swap_b32 v60, v23
    v_max_f32 v60, v60, v23
    v_mov_b32 v23, v60
    s_nop 1
    v_permlane32_swap_b32 v60, v23
    v_max_f32 v60, v60, v23
    v_sub_f32 v92, v92, v60
    v_mul_f32 v92, s40, v92
    v_exp_f32 v92, v92
    s_nop 0
    v_mul_f32 v61, v92, v93
    s_waitcnt vmcnt(3)
L_chk4_1:
    v_xor_b32 v32, v5, v32
    v_xor_b32 v33, v5, v33
    v_xor_b32 v34, v5, v34
    v_xor_b32 v35, v5, v35
    v_or3_b32 v30, v32, v33, v34
    v_or_b32 v30, v30, v35
    v_cmp_ne_u32_sdwa vcc, v30, v10 src0_sel:BYTE_0 src1_sel:DWORD
    s_cbranch_vccnz L_rty4_1
L_ok4_1:
    v_mov_b32_dpp v24, v92 quad_perm:[0,0,0,0] row_mask:0xf bank_mask:0xf
    v_add_f32_dpp v61, v61, v61 quad_perm:[1,0,3,2] row_mask:0xf bank_mask:0xf
    v_pk_mul_f32 v[80:81], v[32:33], v[24:25] op_sel:[0,0] op_sel_hi:[1,0]
    v_pk_mul_f32 v[82:83], v[34:35], v[24:25] op_sel:[0,0] op_sel_hi:[1,0]
    s_waitcnt vmcnt(2)
L_chk4_2:
    v_xor_b32 v36, v5, v36
    v_xor_b32 v37, v5, v37
    v_xor_b32 v38, v5, v38
    v_xor_b32 v39, v5, v39
    v_or3_b32 v30, v36, v37, v38
    v_or_b32 v30, v30, v39
    v_cmp_ne_u32_sdwa vcc, v30, v10 src0_sel:BYTE_0 src1_sel:DWORD
    s_cbranch_vccnz L_rty4_2
L_ok4_2:
    v_mov_b32_dpp v24, v92 quad_perm:[1,1,1,1] row_mask:0xf bank_mask:0xf
    v_add_f32_dpp v61, v61, v61 quad_perm:[2,3,0,1] row_mask:0xf bank_mask:0xf
    v_mov_b32 v23, v61
    v_pk_fma_f32 v[80:81], v[36:37], v[24:25], v[80:81] op_sel:[0,0,0] op_sel_hi:[1,0,1]
    v_pk_fma_f32 v[82:83], v[38:39], v[24:25], v[82:83] op_sel:[0,0,0] op_sel_hi:[1,0,1]
    s_waitcnt vmcnt(1)
L_chk4_3:
    v_xor_b32 v40, v5, v40
    v_xor_b32 v41, v5, v41
    v_xor_b32 v42, v5, v42
    v_xor_b32 v43, v5, v43
    v_or3_b32 v30, v40, v41, v42
    v_or_b32 v30, v30, v43
    v_cmp_ne_u32_sdwa vcc, v30, v10 src0_sel:BYTE_0 src1_sel:DWORD
    s_cbranch_vccnz L_rty4_3
L_ok4_3:
    v_mov_b32_dpp v24, v92 quad_perm:[2,2,2,2] row_mask:0xf bank_mask:0xf
    v_permlane16_swap_b32 v61, v23
    v_add_f32 v61, v61, v23
    v_mov_b32 v23, v61
    v_pk_fma_f32 v[80:81], v[40:41], v[24:25], v[80:81] op_sel:[0,0,0] op_sel_hi:[1,0,1]
    v_pk_fma_f32 v[82:83], v[42:43], v[24:25], v[82:83] op_sel:[0,0,0] op_sel_hi:[1,0,1]
    s_waitcnt vmcnt(0)
L_chk4_4:
    v_xor_b32 v44, v5, v44
    v_xor_b32 v45, v5, v45
    v_xor_b32 v46, v5, v46
    v_xor_b32 v47, v5, v47
    v_or3_b32 v30, v44, v45, v46
    v_or_b32 v30, v30, v47
    v_cmp_ne_u32_sdwa vcc, v30, v10 src0_sel:BYTE_0 src1_sel:DWORD
    s_cbranch_vccnz L_rty4_4
L_ok4_4:
    v_mov_b32_dpp v24, v92 quad_perm:[3,3,3,3] row_mask:0xf bank_mask:0xf
    v_permlane32_swap_b32 v61, v23
    v_add_f32 v61, v61, v23
    v_rcp_f32 v61, v61
    v_pk_fma_f32 v[80:81], v[44:45], v[24:25], v[80:81] op_sel:[0,0,0] op_sel_hi:[1,0,1]
    v_pk_fma_f32 v[82:83], v[46:47], v[24:25], v[82:83] op_sel:[0,0,0] op_sel_hi:[1,0,1]
    s_nop 0
    v_permlane32_swap_b32 v80, v81
    v_permlane32_swap_b32 v82, v83
    v_add_f32 v80, v80, v81
    v_add_f32 v82, v82, v83
    s_nop 1
    v_permlane16_swap_b32 v80, v82
    v_add_f32 v80, v80, v82
    v_mul_f32 v80, v80, v61
    v_cvt_pk_bf16_f32 v80, v80, v80
    ds_write_b32 v19, v80
    ds_read_b128 v[40:43], v20
    ds_read_b128 v[44:47], v20 offset:16
    s_waitcnt lgkmcnt(0)
    v_and_b32 v64, v40, v14
    v_and_b32 v65, v40, v15
    v_and_b32 v66, v40, v16
    v_and_b32 v67, v40, v17
    v_and_b32 v68, v41, v14
    v_and_b32 v69, v41, v15
    v_and_b32 v70, v41, v16
    v_and_b32 v71, v41, v17
    v_mfma_f32_16x16x32_bf16 v[80:83], v[64:67], v[212:215], 0
    v_and_b32 v72, v42, v14
    v_and_b32 v73, v42, v15
    v_and_b32 v74, v42, v16
    v_and_b32 v75, v42, v17
    v_mfma_f32_16x16x32_bf16 v[80:83], v[68:71], v[216:219], v[80:83]
    v_and_b32 v76, v43, v14
    v_and_b32 v77, v43, v15
    v_and_b32 v78, v43, v16
    v_and_b32 v79, v43, v17
    v_mfma_f32_16x16x32_bf16 v[80:83], v[72:75], v[220:223], v[80:83]
    v_and_b32 v64, v44, v14
    v_and_b32 v65, v44, v15
    v_and_b32 v66, v44, v16
    v_and_b32 v67, v44, v17
    v_mfma_f32_16x16x32_bf16 v[80:83], v[76:79], v[224:227], v[80:83]
    v_and_b32 v68, v45, v14
    v_and_b32 v69, v45, v15
    v_and_b32 v70, v45, v16
    v_and_b32 v71, v45, v17
    v_mfma_f32_16x16x32_bf16 v[80:83], v[64:67], v[228:231], v[80:83]
    v_and_b32 v72, v46, v14
    v_and_b32 v73, v46, v15
    v_and_b32 v74, v46, v16
    v_and_b32 v75, v46, v17
    v_mfma_f32_16x16x32_bf16 v[80:83], v[68:71], v[232:235], v[80:83]
    v_and_b32 v76, v47, v14
    v_and_b32 v77, v47, v15
    v_and_b32 v78, v47, v16
    v_and_b32 v79, v47, v17
    v_mfma_f32_16x16x32_bf16 v[80:83], v[72:75], v[236:239], v[80:83]
    s_nop 0
    v_mfma_f32_16x16x32_bf16 v[80:83], v[76:79], v[240:243], v[80:83]
    s_mov_b64 exec, s[46:47]
    s_nop 6
    ds_write_b128 v18, v[80:83] offset:0
    s_mov_b64 exec, -1
    s_cmp_lg_u32 s34, 0
    s_waitcnt lgkmcnt(0)
    s_barrier
    s_cbranch_scc1 L_trskip3
    ds_read2st64_b32 v[32:33], v12 offset0:0 offset1:1
    ds_read2st64_b32 v[34:35], v12 offset0:2 offset1:3
    ds_read2st64_b32 v[36:37], v12 offset0:4 offset1:5
    ds_read2st64_b32 v[38:39], v12 offset0:6 offset1:7
    s_waitcnt lgkmcnt(2)
    v_pk_add_f32 v[32:33], v[32:33], v[34:35]
    s_waitcnt lgkmcnt(0)
    v_pk_add_f32 v[36:37], v[36:37], v[38:39]
    v_pk_add_f32 v[32:33], v[32:33], v[36:37]
    v_add_f32 v32, v32, v33
    v_bfi_b32 v32, s42, v5, v32
    s_nop 1
    v_mov_b32_dpp v40, v32 quad_perm:[0,0,0,0] row_mask:0xf bank_mask:0xf
    v_mov_b32_dpp v41, v32 quad_perm:[1,1,1,1] row_mask:0xf bank_mask:0xf
    v_mov_b32_dpp v42, v32 quad_perm:[2,2,2,2] row_mask:0xf bank_mask:0xf
    v_mov_b32_dpp v43, v32 quad_perm:[3,3,3,3] row_mask:0xf bank_mask:0xf
    s_mov_b64 exec, s[62:63]
    global_store_dwordx4 v96, v[40:43], s[30:31] offset:0 sc1
    s_mov_b64 exec, -1
L_trskip3:
    s_barrier
    global_store_dwordx2 v31, v[84:85], s[30:31] sc1
    s_mov_b64 exec, 1
    global_store_dwordx4 v11, v[88:91], s[30:31] sc1
    s_mov_b64 exec, -1
    s_cmp_ge_u32 s33, 2
    s_cbranch_scc1 L_done
    s_lshl_b32 s43, s32, 1
    s_add_u32 s43, s43, s33
    s_lshl_b32 s35, s43, 7
    s_mul_i32 s38, s34, 69632
    s_add_u32 s35, s35, s38
    s_add_u32 s35, s35, 737280
    v_mul_u32_u24 v22, 2176, v2
    v_lshl_add_u32 v22, v3, 4, v22
    v_add_u32 v22, s35, v22
    v_add_u32 v23, 17408, v22
    v_add_u32 v24, 34816, v22
    v_add_u32 v25, 52224, v22
    s_lshl_b32 s36, s34, 7
    s_add_u32 s36, s36, 6272
    v_lshlrev_b32 v26, 4, v3
    v_lshl_add_u32 v26, v7, 2, v26
    v_add_u32 v26, s36, v26
    s_mov_b32 s39, 20000
    global_load_dwordx4 v[32:35], v22, s[30:31] offset:0 sc1
    global_load_dwordx4 v[36:39], v23, s[30:31] offset:0 sc1
    global_load_dwordx4 v[40:43], v24, s[30:31] offset:0 sc1
    global_load_dwordx4 v[44:47], v25, s[30:31] offset:0 sc1
    s_waitcnt vmcnt(3)
L_chk5_0:
    v_xor_b32 v32, v5, v32
    v_xor_b32 v33, v5, v33
    v_xor_b32 v34, v5, v34
    v_xor_b32 v35, v5, v35
    v_or3_b32 v30, v32, v33, v34
    v_or_b32 v30, v30, v35
    v_cmp_ne_u32_sdwa vcc, v30, v10 src0_sel:BYTE_0 src1_sel:DWORD
    s_cbranch_vccnz L_rty5_0
L_ok5_0:
    s_waitcnt vmcnt(2)
L_chk5_1:
    v_xor_b32 v36, v5, v36
    v_xor_b32 v37, v5, v37
    v_xor_b32 v38, v5, v38
    v_xor_b32 v39, v5, v39
    v_or3_b32 v30, v36, v37, v38
    v_or_b32 v30, v30, v39
    v_cmp_ne_u32_sdwa vcc, v30, v10 src0_sel:BYTE_0 src1_sel:DWORD
    s_cbranch_vccnz L_rty5_1
L_ok5_1:
    v_pk_add_f32 v[32:33], v[32:33], v[36:37]
    v_pk_add_f32 v[34:35], v[34:35], v[38:39]
    s_waitcnt vmcnt(1)
L_chk5_2:
    v_xor_b32 v40, v5, v40
    v_xor_b32 v41, v5, v41
    v_xor_b32 v42, v5, v42
    v_xor_b32 v43, v5, v43
    v_or3_b32 v30, v40, v41, v42
    v_or_b32 v30, v30, v43
    v_cmp_ne_u32_sdwa vcc, v30, v10 src0_sel:BYTE_0 src1_sel:DWORD
    s_cbranch_vccnz L_rty5_2
L_ok5_2:
    v_pk_add_f32 v[32:33], v[32:33], v[40:41]
    v_pk_add_f32 v[34:35], v[34:35], v[42:43]
    s_waitcnt vmcnt(0)
L_chk5_3:
    v_xor_b32 v44, v5, v44
    v_xor_b32 v45, v5, v45
    v_xor_b32 v46, v5, v46
    v_xor_b32 v47, v5, v47
    v_or3_b32 v30, v44, v45, v46
    v_or_b32 v30, v30, v47
    v_cmp_ne_u32_sdwa vcc, v30, v10 src0_sel:BYTE_0 src1_sel:DWORD
    s_cbranch_vccnz L_rty5_3
L_ok5_3:
    v_pk_add_f32 v[32:33], v[32:33], v[44:45]
    v_pk_add_f32 v[34:35], v[34:35], v[46:47]
    s_nop 0
    v_permlane32_swap_b32 v32, v33
    v_permlane32_swap_b32 v34, v35
    v_add_f32 v32, v32, v33
    v_add_f32 v34, v34, v35
    s_nop 1
    v_permlane16_swap_b32 v32, v34
    v_add_f32 v32, v32, v34
    s_nop 1
    v_add_f32_dpp v32, v32, v32 row_ror:8 row_mask:0xf bank_mask:0xf
    ds_write_b32 v26, v32
    s_waitcnt lgkmcnt(0)
    s_barrier
L_done:
    s_endpgm
L_rty4_0:
    s_cmp_eq_u32 s39, 0
    s_cbranch_scc1 L_ok4_0
    s_sub_u32 s39, s39, 1
    s_and_b32 s35, s39, 31
    s_cselect_b32 s35, 983040, 0
    s_cbranch_scc1 L_nst4_0
    global_store_dwordx2 v31, v[84:85], s[30:31] sc1
    s_mov_b64 exec, 1
    global_store_dwordx4 v11, v[88:91], s[30:31] sc1
    s_mov_b64 exec, -1
L_nst4_0:
    s_add_u32 s60, s30, s35
    s_addc_u32 s61, s31, 0
    global_load_dwordx4 v[92:95], v245, s[60:61] offset:0 sc1
    global_load_dwordx4 v[32:35], v244, s[60:61] offset:-2176 sc1
    global_load_dwordx4 v[36:39], v244, s[60:61] offset:0 sc1
    global_load_dwordx4 v[40:43], v97, s[60:61] offset:-2176 sc1
    global_load_dwordx4 v[44:47], v97, s[60:61] offset:0 sc1
    s_waitcnt vmcnt(4)
    s_branch L_chk4_0
L_rty4_1:
    s_cmp_eq_u32 s39, 0
    s_cbranch_scc1 L_ok4_1
    s_sub_u32 s39, s39, 1
    s_and_b32 s35, s39, 31
    s_cselect_b32 s35, 983040, 0
    s_cbranch_scc1 L_nst4_1
    global_store_dwordx2 v31, v[84:85], s[30:31] sc1
    s_mov_b64 exec, 1
    global_store_dwordx4 v11, v[88:91], s[30:31] sc1
    s_mov_b64 exec, -1
L_nst4_1:
    s_add_u32 s60, s30, s35
    s_addc_u32 s61, s31, 0
    global_load_dwordx4 v[32:35], v244, s[60:61] offset:-2176 sc1
    global_load_dwordx4 v[36:39], v244, s[60:61] offset:0 sc1
    global_load_dwordx4 v[40:43], v97, s[60:61] offset:-2176 sc1
    global_load_dwordx4 v[44:47], v97, s[60:61] offset:0 sc1
    s_waitcnt vmcnt(3)
    s_branch L_chk4_1
L_rty4_2:
    s_cmp_eq_u32 s39, 0
    s_cbranch_scc1 L_ok4_2
    s_sub_u32 s39, s39, 1
    s_and_b32 s35, s39, 31
    s_cselect_b32 s35, 983040, 0
    s_cbranch_scc1 L_nst4_2
    global_store_dwordx2 v31, v[84:85], s[30:31] sc1
    s_mov_b64 exec, 1
    global_store_dwordx4 v11, v[88:91], s[30:31] sc1
    s_mov_b64 exec, -1
L_nst4_2:
    s_add_u32 s60, s30, s35
    s_addc_u32 s61, s31, 0
    global_load_dwordx4 v[36:39], v244, s[60:61] offset:0 sc1
    global_load_dwordx4 v[40:43], v97, s[60:61] offset:-2176 sc1
    global_load_dwordx4 v[44:47], v97, s[60:61] offset:0 sc1
    s_waitcnt vmcnt(2)
    s_branch L_chk4_2
L_rty4_3:
    s_cmp_eq_u32 s39, 0
    s_cbranch_scc1 L_ok4_3
    s_sub_u32 s39, s39, 1
    s_and_b32 s35, s39, 31
    s_cselect_b32 s35, 983040, 0
    s_cbranch_scc1 L_nst4_3
    global_store_dwordx2 v31, v[84:85], s[30:31] sc1
    s_mov_b64 exec, 1
    global_store_dwordx4 v11, v[88:91], s[30:31] sc1
    s_mov_b64 exec, -1
L_nst4_3:
    s_add_u32 s60, s30, s35
    s_addc_u32 s61, s31, 0
    global_load_dwordx4 v[40:43], v97, s[60:61] offset:-2176 sc1
    global_load_dwordx4 v[44:47], v97, s[60:61] offset:0 sc1
    s_waitcnt vmcnt(1)
    s_branch L_chk4_3
L_rty4_4:
    s_cmp_eq_u32 s39, 0
    s_cbranch_scc1 L_ok4_4
    s_sub_u32 s39, s39, 1
    s_and_b32 s35, s39, 31
    s_cselect_b32 s35, 983040, 0
    s_cbranch_scc1 L_nst4_4
    global_store_dwordx2 v31, v[84:85], s[30:31] sc1
    s_mov_b64 exec, 1
    global_store_dwordx4 v11, v[88:91], s[30:31] sc1
    s_mov_b64 exec, -1
L_nst4_4:
    s_add_u32 s60, s30, s35
    s_addc_u32 s61, s31, 0
    global_load_dwordx4 v[44:47], v97, s[60:61] offset:0 sc1
    s_waitcnt vmcnt(0)
    s_branch L_chk4_4
L_rty5_0:
    s_cmp_eq_u32 s39, 0
    s_cbranch_scc1 L_ok5_0
    s_sub_u32 s39, s39, 1
    global_load_dwordx4 v[32:35], v22, s[30:31] offset:0 sc1
    global_load_dwordx4 v[36:39], v23, s[30:31] offset:0 sc1
    global_load_dwordx4 v[40:43], v24, s[30:31] offset:0 sc1
    global_load_dwordx4 v[44:47], v25, s[30:31] offset:0 sc1
    s_waitcnt vmcnt(3)
    s_branch L_chk5_0
L_rty5_1:
    s_cmp_eq_u32 s39, 0
    s_cbranch_scc1 L_ok5_1
    s_sub_u32 s39, s39, 1
    global_load_dwordx4 v[36:39], v23, s[30:31] offset:0 sc1
    global_load_dwordx4 v[40:43], v24, s[30:31] offset:0 sc1
    global_load_dwordx4 v[44:47], v25, s[30:31] offset:0 sc1
    s_waitcnt vmcnt(2)
    s_branch L_chk5_1
L_rty5_2:
    s_cmp_eq_u32 s39, 0
    s_cbranch_scc1 L_ok5_2
    s_sub_u32 s39, s39, 1
    global_load_dwordx4 v[40:43], v24, s[30:31] offset:0 sc1
    global_load_dwordx4 v[44:47], v25, s[30:31] offset:0 sc1
    s_waitcnt vmcnt(1)
    s_branch L_chk5_2
L_rty5_3:
    s_cmp_eq_u32 s39, 0
    s_cbranch_scc1 L_ok5_3
    s_sub_u32 s39, s39, 1
    global_load_dwordx4 v[44:47], v25, s[30:31] offset:0 sc1
    s_waitcnt vmcnt(0)
    s_branch L_chk5_3
L_helper:
    v_bfe_u32 v25, v1, 4, 1
    v_lshrrev_b32 v26, 5, v1
    v_lshl_add_u32 v7, v25, 1, v26
    s_mov_b32 s41, 0xffff0000
    v_bfe_u32 v22, v1, 2, 2
    v_and_b32 v23, 3, v1
    s_lshl_b32 s35, s32, 12
    s_add_u32 s35, s35, 65536
    v_lshlrev_b32 v84, 10, v22
    v_lshl_add_u32 v84, v26, 9, v84
    v_lshl_add_u32 v84, v25, 6, v84
    v_lshl_add_u32 v84, v23, 4, v84
    v_add_u32 v84, s35, v84
    s_lshl_b32 s36, s32, 4
    s_add_u32 s36, s36, s33
    s_mul_i32 s36, s36, 2176
    s_add_u32 s36, s36, 1114112
    v_lshl_add_u32 v25, v1, 5, s36
    s_lshl_b32 s36, s32, 10
    s_add_u32 s36, s36, 1392640
    v_add_u32 v26, s36, v4
    s_waitcnt lgkmcnt(0)
    global_load_dword v6, v10, s[30:31] sc1
    global_load_dword v11, v25, s[30:31]
    global_load_dword v11, v26, s[30:31]
    s_add_u32 s60, s30, 983040
    s_addc_u32 s61, s31, 0
    s_waitcnt vmcnt(2)
    v_add_u32 v6, 1, v6
    v_and_b32 v5, 0xff, v6
    s_mov_b32 s39, 20000
    global_load_dwordx4 v[32:35], v84, s[60:61] offset:0 sc1
    global_load_dwordx4 v[36:39], v84, s[60:61] offset:128 sc1
    global_load_dwordx4 v[40:43], v84, s[60:61] offset:256 sc1
    global_load_dwordx4 v[44:47], v84, s[60:61] offset:384 sc1
    s_waitcnt vmcnt(3)
L_chk6_0:
    v_xor_b32 v32, v5, v32
    v_xor_b32 v33, v5, v33
    v_xor_b32 v34, v5, v34
    v_xor_b32 v35, v5, v35
    v_or3_b32 v30, v32, v33, v34
    v_or_b32 v30, v30, v35
    v_cmp_ne_u32_sdwa vcc, v30, v10 src0_sel:BYTE_0 src1_sel:DWORD
    s_cbranch_vccnz L_rty6_0
L_ok6_0:
    s_waitcnt vmcnt(2)
L_chk6_1:
    v_xor_b32 v36, v5, v36
    v_xor_b32 v37, v5, v37
    v_xor_b32 v38, v5, v38
    v_xor_b32 v39, v5, v39
    v_or3_b32 v30, v36, v37, v38
    v_or_b32 v30, v30, v39
    v_cmp_ne_u32_sdwa vcc, v30, v10 src0_sel:BYTE_0 src1_sel:DWORD
    s_cbranch_vccnz L_rty6_1
L_ok6_1:
    s_waitcnt vmcnt(1)
L_chk6_2:
    v_xor_b32 v40, v5, v40
    v_xor_b32 v41, v5, v41
    v_xor_b32 v42, v5, v42
    v_xor_b32 v43, v5, v43
    v_or3_b32 v30, v40, v41, v42
    v_or_b32 v30, v30, v43
    v_cmp_ne_u32_sdwa vcc, v30, v10 src0_sel:BYTE_0 src1_sel:DWORD
    s_cbranch_vccnz L_rty6_2
L_ok6_2:
    v_pk_add_f32 v[32:33], v[32:33], v[40:41]
    v_pk_add_f32 v[34:35], v[34:35], v[42:43]
    s_waitcnt vmcnt(0)
L_chk6_3:
    v_xor_b32 v44, v5, v44
    v_xor_b32 v45, v5, v45
    v_xor_b32 v46, v5, v46
    v_xor_b32 v47, v5, v47
    v_or3_b32 v30, v44, v45, v46
    v_or_b32 v30, v30, v47
    v_cmp_ne_u32_sdwa vcc, v30, v10 src0_sel:BYTE_0 src1_sel:DWORD
    s_cbranch_vccnz L_rty6_3
L_ok6_3:
    v_pk_add_f32 v[36:37], v[36:37], v[44:45]
    v_pk_add_f32 v[38:39], v[38:39], v[46:47]
    v_cvt_pk_bf16_f32 v64, v32, v33
    v_cvt_pk_bf16_f32 v65, v34, v35
    v_cvt_pk_bf16_f32 v66, v36, v37
    v_cvt_pk_bf16_f32 v67, v38, v39
    ds_write_b128 v4, v[64:67] offset:5120
    s_cmp_ge_u32 s33, 2
    s_waitcnt lgkmcnt(0)
    s_barrier
    s_cbranch_scc1 L_hdone
    s_lshl_b32 s43, s32, 1
    s_add_u32 s43, s43, s33
    s_lshl_b32 s35, s43, 7
    v_mul_u32_u24 v22, 2176, v2
    v_lshl_add_u32 v22, v3, 4, v22
    v_add_u32 v22, s35, v22
    v_lshl_add_u32 v23, v3, 2, v7
    v_add_u32 v84, 688128, v22
    v_add_u32 v85, 17408, v84
    v_lshl_add_u32 v24, v23, 2, s35
    s_lshr_b32 s36, s43, 1
    s_and_b32 s37, s43, 1
    s_lshl_b32 s36, s36, 10
    s_lshl_b32 s38, s37, 7
    s_add_u32 s36, s36, s38
    s_add_u32 s36, s36, 655360
    v_lshl_add_u32 v86, v23, 2, s36
    v_add_u32 v89, 24576, v86
    v_lshrrev_b32 v87, 1, v24
    v_lshlrev_b32 v88, 2, v23
    v_mov_b32 v92, 0
    s_mov_b32 s56, 0x00ff00ff
    s_mov_b32 s57, 0x00ff00ff
    s_barrier
    s_barrier
    s_barrier
    global_load_short_d16_hi v92, v87, s[4:5]
    s_mov_b32 s39, 20000
    global_load_dword v44, v86, s[30:31] offset:0 sc1
    global_load_dword v45, v86, s[30:31] offset:256 sc1
    global_load_dword v46, v86, s[30:31] offset:512 sc1
    global_load_dword v47, v86, s[30:31] offset:768 sc1
    global_load_dword v48, v89, s[30:31] offset:0 sc1
    global_load_dword v49, v89, s[30:31] offset:256 sc1
    global_load_dword v50, v89, s[30:31] offset:512 sc1
    global_load_dword v51, v89, s[30:31] offset:768 sc1
    s_waitcnt vmcnt(7)
L_chk7_0:
    v_xor_b32 v44, v5, v44
    v_cmp_ne_u32_sdwa vcc, v44, v10 src0_sel:BYTE_0 src1_sel:DWORD
    s_cbranch_vccnz L_rty7_0
L_ok7_0:
    s_waitcnt vmcnt(6)
L_chk7_1:
    v_xor_b32 v45, v5, v45
    v_cmp_ne_u32_sdwa vcc, v45, v10 src0_sel:BYTE_0 src1_sel:DWORD
    s_cbranch_vccnz L_rty7_1
L_ok7_1:
    s_waitcnt vmcnt(5)
L_chk7_2:
    v_xor_b32 v46, v5, v46
    v_cmp_ne_u32_sdwa vcc, v46, v10 src0_sel:BYTE_0 src1_sel:DWORD
    s_cbranch_vccnz L_rty7_2
L_ok7_2:
    s_waitcnt vmcnt(4)
L_chk7_3:
    v_xor_b32 v47, v5, v47
    v_cmp_ne_u32_sdwa vcc, v47, v10 src0_sel:BYTE_0 src1_sel:DWORD
    s_cbranch_vccnz L_rty7_3
L_ok7_3:
    s_waitcnt vmcnt(3)
L_chk7_4:
    v_xor_b32 v48, v5, v48
    v_cmp_ne_u32_sdwa vcc, v48, v10 src0_sel:BYTE_0 src1_sel:DWORD
    s_cbranch_vccnz L_rty7_4
L_ok7_4:
    s_waitcnt vmcnt(2)
L_chk7_5:
    v_xor_b32 v49, v5, v49
    v_cmp_ne_u32_sdwa vcc, v49, v10 src0_sel:BYTE_0 src1_sel:DWORD
    s_cbranch_vccnz L_rty7_5
L_ok7_5:
    s_waitcnt vmcnt(1)
L_chk7_6:
    v_xor_b32 v50, v5, v50
    v_cmp_ne_u32_sdwa vcc, v50, v10 src0_sel:BYTE_0 src1_sel:DWORD
    s_cbranch_vccnz L_rty7_6
L_ok7_6:
    s_waitcnt vmcnt(0)
L_chk7_7:
    v_xor_b32 v51, v5, v51
    v_cmp_ne_u32_sdwa vcc, v51, v10 src0_sel:BYTE_0 src1_sel:DWORD
    s_cbranch_vccnz L_rty7_7
L_ok7_7:
    v_pk_add_f32 v[44:45], v[44:45], v[46:47]
    v_add_f32 v44, v44, v45
    v_cvt_pk_bf16_f32 v40, v44, v44
    v_and_b32 v40, s41, v40
    v_pk_add_f32 v[48:49], v[48:49], v[50:51]
    v_add_f32 v48, v48, v49
    v_cvt_pk_bf16_f32 v41, v48, v48
    v_and_b32 v41, s41, v41
    s_mov_b32 s39, 20000
    global_load_dwordx4 v[32:35], v84, s[30:31] offset:0 sc1
    global_load_dwordx4 v[36:39], v85, s[30:31] offset:0 sc1
    s_waitcnt vmcnt(1)
L_chk8_0:
    v_xor_b32 v32, v5, v32
    v_xor_b32 v33, v5, v33
    v_xor_b32 v34, v5, v34
    v_xor_b32 v35, v5, v35
    v_or3_b32 v30, v32, v33, v34
    v_or_b32 v30, v30, v35
    v_cmp_ne_u32_sdwa vcc, v30, v10 src0_sel:BYTE_0 src1_sel:DWORD
    s_cbranch_vccnz L_rty8_0
L_ok8_0:
    s_waitcnt vmcnt(0)
L_chk8_1:
    v_xor_b32 v36, v5, v36
    v_xor_b32 v37, v5, v37
    v_xor_b32 v38, v5, v38
    v_xor_b32 v39, v5, v39
    v_or3_b32 v30, v36, v37, v38
    v_or_b32 v30, v30, v39
    v_cmp_ne_u32_sdwa vcc, v30, v10 src0_sel:BYTE_0 src1_sel:DWORD
    s_cbranch_vccnz L_rty8_1
L_ok8_1:
    v_pk_add_f32 v[32:33], v[32:33], v[36:37]
    v_pk_add_f32 v[34:35], v[34:35], v[38:39]
    s_nop 0
    v_permlane32_swap_b32 v32, v33
    v_permlane32_swap_b32 v34, v35
    v_add_f32 v32, v32, v33
    v_add_f32 v34, v34, v35
    s_nop 1
    v_permlane16_swap_b32 v32, v34
    v_add_f32 v32, v32, v34
    s_nop 1
    v_add_f32_dpp v32, v32, v32 row_ror:8 row_mask:0xf bank_mask:0xf
    v_cvt_pk_bf16_f32 v32, v32, v32
    v_and_b32 v32, s41, v32
    v_mul_f32 v32, v40, v32
    v_cvt_pk_bf16_f32 v32, v32, v32
    v_and_b32 v32, s41, v32
    v_add_f32 v32, v92, v32
    v_cvt_pk_bf16_f32 v92, v32, v32
    v_and_b32 v92, s41, v92
    s_barrier
    ds_read_b32 v32, v88 offset:6272
    ds_read_b32 v33, v88 offset:6400
    ds_read_b32 v34, v88 offset:6528
    ds_read_b32 v35, v88 offset:6656
    s_waitcnt lgkmcnt(0)
    v_pk_add_f32 v[32:33], v[32:33], v[34:35]
    v_add_f32 v32, v32, v33
    v_cvt_pk_bf16_f32 v32, v32, v32
    v_and_b32 v32, s41, v32
    v_mul_f32 v32, v41, v32
    v_cvt_pk_bf16_f32 v32, v32, v32
    v_and_b32 v32, s41, v32
    v_add_f32 v32, v92, v32
    v_cvt_pk_bf16_f32 v32, v32, v32
    s_mov_b64 exec, s[56:57]
    global_store_short v87, v32, s[26:27]
    s_cmp_lg_u32 s43, 0
    s_cbranch_scc1 L_hdone
    s_mov_b64 exec, 1
    global_store_dword v10, v6, s[30:31] sc1
L_hdone:
    s_endpgm
L_rty6_0:
    s_cmp_eq_u32 s39, 0
    s_cbranch_scc1 L_ok6_0
    s_sub_u32 s39, s39, 1
    s_and_b32 s35, s39, 31
    s_cselect_b32 s35, 983040, 0
    s_cbranch_scc1 L_nst6_0
L_nst6_0:
    s_add_u32 s60, s30, s35
    s_addc_u32 s61, s31, 0
    global_load_dwordx4 v[32:35], v84, s[60:61] offset:0 sc1
    global_load_dwordx4 v[36:39], v84, s[60:61] offset:128 sc1
    global_load_dwordx4 v[40:43], v84, s[60:61] offset:256 sc1
    global_load_dwordx4 v[44:47], v84, s[60:61] offset:384 sc1
    s_waitcnt vmcnt(3)
    s_branch L_chk6_0
L_rty6_1:
    s_cmp_eq_u32 s39, 0
    s_cbranch_scc1 L_ok6_1
    s_sub_u32 s39, s39, 1
    s_and_b32 s35, s39, 31
    s_cselect_b32 s35, 983040, 0
    s_cbranch_scc1 L_nst6_1
L_nst6_1:
    s_add_u32 s60, s30, s35
    s_addc_u32 s61, s31, 0
    global_load_dwordx4 v[36:39], v84, s[60:61] offset:128 sc1
    global_load_dwordx4 v[40:43], v84, s[60:61] offset:256 sc1
    global_load_dwordx4 v[44:47], v84, s[60:61] offset:384 sc1
    s_waitcnt vmcnt(2)
    s_branch L_chk6_1
L_rty6_2:
    s_cmp_eq_u32 s39, 0
    s_cbranch_scc1 L_ok6_2
    s_sub_u32 s39, s39, 1
    s_and_b32 s35, s39, 31
    s_cselect_b32 s35, 983040, 0
    s_cbranch_scc1 L_nst6_2
L_nst6_2:
    s_add_u32 s60, s30, s35
    s_addc_u32 s61, s31, 0
    global_load_dwordx4 v[40:43], v84, s[60:61] offset:256 sc1
    global_load_dwordx4 v[44:47], v84, s[60:61] offset:384 sc1
    s_waitcnt vmcnt(1)
    s_branch L_chk6_2
L_rty6_3:
    s_cmp_eq_u32 s39, 0
    s_cbranch_scc1 L_ok6_3
    s_sub_u32 s39, s39, 1
    s_and_b32 s35, s39, 31
    s_cselect_b32 s35, 983040, 0
    s_cbranch_scc1 L_nst6_3
L_nst6_3:
    s_add_u32 s60, s30, s35
    s_addc_u32 s61, s31, 0
    global_load_dwordx4 v[44:47], v84, s[60:61] offset:384 sc1
    s_waitcnt vmcnt(0)
    s_branch L_chk6_3
L_rty7_0:
    s_cmp_eq_u32 s39, 0
    s_cbranch_scc1 L_ok7_0
    s_sub_u32 s39, s39, 1
    global_load_dword v44, v86, s[30:31] offset:0 sc1
    global_load_dword v45, v86, s[30:31] offset:256 sc1
    global_load_dword v46, v86, s[30:31] offset:512 sc1
    global_load_dword v47, v86, s[30:31] offset:768 sc1
    global_load_dword v48, v89, s[30:31] offset:0 sc1
    global_load_dword v49, v89, s[30:31] offset:256 sc1
    global_load_dword v50, v89, s[30:31] offset:512 sc1
    global_load_dword v51, v89, s[30:31] offset:768 sc1
    s_waitcnt vmcnt(7)
    s_branch L_chk7_0
L_rty7_1:
    s_cmp_eq_u32 s39, 0
    s_cbranch_scc1 L_ok7_1
    s_sub_u32 s39, s39, 1
    global_load_dword v45, v86, s[30:31] offset:256 sc1
    global_load_dword v46, v86, s[30:31] offset:512 sc1
    global_load_dword v47, v86, s[30:31] offset:768 sc1
    global_load_dword v48, v89, s[30:31] offset:0 sc1
    global_load_dword v49, v89, s[30:31] offset:256 sc1
    global_load_dword v50, v89, s[30:31] offset:512 sc1
    global_load_dword v51, v89, s[30:31] offset:768 sc1
    s_waitcnt vmcnt(6)
    s_branch L_chk7_1
L_rty7_2:
    s_cmp_eq_u32 s39, 0
    s_cbranch_scc1 L_ok7_2
    s_sub_u32 s39, s39, 1
    global_load_dword v46, v86, s[30:31] offset:512 sc1
    global_load_dword v47, v86, s[30:31] offset:768 sc1
    global_load_dword v48, v89, s[30:31] offset:0 sc1
    global_load_dword v49, v89, s[30:31] offset:256 sc1
    global_load_dword v50, v89, s[30:31] offset:512 sc1
    global_load_dword v51, v89, s[30:31] offset:768 sc1
    s_waitcnt vmcnt(5)
    s_branch L_chk7_2
L_rty7_3:
    s_cmp_eq_u32 s39, 0
    s_cbranch_scc1 L_ok7_3
    s_sub_u32 s39, s39, 1
    global_load_dword v47, v86, s[30:31] offset:768 sc1
    global_load_dword v48, v89, s[30:31] offset:0 sc1
    global_load_dword v49, v89, s[30:31] offset:256 sc1
    global_load_dword v50, v89, s[30:31] offset:512 sc1
    global_load_dword v51, v89, s[30:31] offset:768 sc1
    s_waitcnt vmcnt(4)
    s_branch L_chk7_3
L_rty7_4:
    s_cmp_eq_u32 s39, 0
    s_cbranch_scc1 L_ok7_4
    s_sub_u32 s39, s39, 1
    global_load_dword v48, v89, s[30:31] offset:0 sc1
    global_load_dword v49, v89, s[30:31] offset:256 sc1
    global_load_dword v50, v89, s[30:31] offset:512 sc1
    global_load_dword v51, v89, s[30:31] offset:768 sc1
    s_waitcnt vmcnt(3)
    s_branch L_chk7_4
L_rty7_5:
    s_cmp_eq_u32 s39, 0
    s_cbranch_scc1 L_ok7_5
    s_sub_u32 s39, s39, 1
    global_load_dword v49, v89, s[30:31] offset:256 sc1
    global_load_dword v50, v89, s[30:31] offset:512 sc1
    global_load_dword v51, v89, s[30:31] offset:768 sc1
    s_waitcnt vmcnt(2)
    s_branch L_chk7_5
L_rty7_6:
    s_cmp_eq_u32 s39, 0
    s_cbranch_scc1 L_ok7_6
    s_sub_u32 s39, s39, 1
    global_load_dword v50, v89, s[30:31] offset:512 sc1
    global_load_dword v51, v89, s[30:31] offset:768 sc1
    s_waitcnt vmcnt(1)
    s_branch L_chk7_6
L_rty7_7:
    s_cmp_eq_u32 s39, 0
    s_cbranch_scc1 L_ok7_7
    s_sub_u32 s39, s39, 1
    global_load_dword v51, v89, s[30:31] offset:768 sc1
    s_waitcnt vmcnt(0)
    s_branch L_chk7_7
L_rty8_0:
    s_cmp_eq_u32 s39, 0
    s_cbranch_scc1 L_ok8_0
    s_sub_u32 s39, s39, 1
    global_load_dwordx4 v[32:35], v84, s[30:31] offset:0 sc1
    global_load_dwordx4 v[36:39], v85, s[30:31] offset:0 sc1
    s_waitcnt vmcnt(1)
    s_branch L_chk8_0
L_rty8_1:
    s_cmp_eq_u32 s39, 0
    s_cbranch_scc1 L_ok8_1
    s_sub_u32 s39, s39, 1
    global_load_dwordx4 v[36:39], v85, s[30:31] offset:0 sc1
    s_waitcnt vmcnt(0)
    s_branch L_chk8_1
L_end:
    s_endpgm
.fill (15*1024 - (. - adaLN_cond__sliding_block_cached__glu_gated_bilinear__decode_kernel))/4, 4, 0xbf810000
.section .rodata,"a"
.p2align 6
.amdhsa_kernel adaLN_cond__sliding_block_cached__glu_gated_bilinear__decode_kernel
  .amdhsa_next_free_vgpr 256
  .amdhsa_next_free_sgpr 100
  .amdhsa_accum_offset 256
  .amdhsa_group_segment_fixed_size 0
  .amdhsa_kernarg_size 112
  .amdhsa_user_sgpr_count 2
  .amdhsa_user_sgpr_kernarg_segment_ptr 1
  .amdhsa_system_sgpr_workgroup_id_x 1
  .amdhsa_float_denorm_mode_32 3
.end_amdhsa_kernel
```
